```python
import torch

def _softmax(x, axis=-1):
    return torch.softmax(x, dim=axis)
def _gelu(x):
    return torch.nn.functional.gelu(x, approximate="tanh")
def _silu(x):
    return torch.nn.functional.silu(x)
def _sigmoid(x):
    return torch.sigmoid(x)
def _layernorm(x, axis=-1, eps=1e-5):
    m = x.mean(dim=axis, keepdim=True)
    v = x.var(dim=axis, keepdim=True, unbiased=False)
    return (x - m) / torch.sqrt(v + eps)
def _scatter_add(tgt, idx, src, axis=0):
    return tgt.clone().index_add_(axis, idx, src)
def _segment_sum(src, seg, n):
    out = torch.zeros((n,) + src.shape[1:], dtype=src.dtype)
    return out.index_add_(0, seg, src)
def _pad(x, pw):
    flat = tuple(v for pair in reversed(pw) for v in pair)
    return torch.nn.functional.pad(x, flat)

kernel_name = 'concat_heads__gqa_block_cached__mha_block_cached__decode'

def setup_inputs():

    _w = (lambda a: (lambda t: t.to(torch.bfloat16) if t.is_floating_point() else t)(torch.as_tensor(a)))
    def _A_setup():
        B, Sq, D = 1, 1, 448
        Hq, Hkv, Sk, Dh = 16, 8, 32768, 256
        assert Hq % Hkv == 0, (Hq, Hkv)
        return {
            "x": _w((lambda *s: torch.randn(*s, dtype=torch.bfloat16) * 0.8)(B, Sq, D)),
            "k_cache": _w((lambda *s: torch.randn(*s, dtype=torch.bfloat16) * 1.6)(B, Hkv, Sk, Dh)),
            "v_cache": _w((lambda *s: torch.randn(*s, dtype=torch.bfloat16) * 0.2)(B, Hkv, Sk, Dh)),
            "wq": _w((lambda *s: torch.randn(*s, dtype=torch.bfloat16) * 1.6)(D, Hq * Dh) * (D ** -0.5)),
            "wo": _w((lambda *s: torch.randn(*s, dtype=torch.bfloat16) * 0.2)(Hq * Dh, D) * ((Hq * Dh) ** -0.5)),
        }
    _A_in = _A_setup()

    def _B_setup():
        B, Sq, D = 1, 1, 448
        H, Sk, Dh = 16, 32768, 256
        return {
            "x": _w((lambda *s: torch.randn(*s, dtype=torch.bfloat16) * 0.8)(B, Sq, D)),
            "k_cache": _w((lambda *s: torch.randn(*s, dtype=torch.bfloat16) * 1.6)(B, H, Sk, Dh)),
            "v_cache": _w((lambda *s: torch.randn(*s, dtype=torch.bfloat16) * 0.2)(B, H, Sk, Dh)),
            "wq": _w((lambda *s: torch.randn(*s, dtype=torch.bfloat16) * 1.6)(D, H * Dh) * (D ** -0.5)),
            "wo": _w((lambda *s: torch.randn(*s, dtype=torch.bfloat16) * 0.2)(H * Dh, D) * ((H * Dh) ** -0.5)),
        }
    _B_in = _B_setup()

    return {
        "A_x": _A_in["x"],
        "A_k_cache": _A_in["k_cache"],
        "A_v_cache": _A_in["v_cache"],
        "A_wq": _A_in["wq"],
        "A_wo": _A_in["wo"],
        "B_x": _B_in["x"],
        "B_k_cache": _B_in["k_cache"],
        "B_v_cache": _B_in["v_cache"],
        "B_wq": _B_in["wq"],
        "B_wo": _B_in["wo"],
    }

def reference(A_x, A_k_cache, A_v_cache, A_wq, A_wo, B_x, B_k_cache, B_v_cache, B_wq, B_wo):
    def _A_ref(x, k_cache, v_cache, wq, wo):
        B, Sq, D = x.shape
        Hq, Dh = 16, 256
        Hkv = k_cache.shape[1]
        rep = Hq // Hkv
        q = (lambda x, *d: x.permute(*d))((x @ wq).reshape(B, Sq, Hq, Dh), 0, 2, 1, 3)
        k = (lambda x, n, axis: torch.repeat_interleave(x, n, dim=axis))(k_cache, rep, axis=1)
        v = (lambda x, n, axis: torch.repeat_interleave(x, n, dim=axis))(v_cache, rep, axis=1)
        scores = torch.einsum("bhqd,bhkd->bhqk", q, k) * (Dh ** -0.5)
        p = _softmax(scores, axis=-1)
        o = torch.einsum("bhqk,bhkd->bhqd", p, v)
        return (lambda x, *d: x.permute(*d))(o, 0, 2, 1, 3).reshape(B, Sq, Hq * Dh) @ wo

    def _B_ref(x, k_cache, v_cache, wq, wo):
        B, Sq, D = x.shape
        H, Dh = 16, 256
        q = (lambda x, *d: x.permute(*d))((x @ wq).reshape(B, Sq, H, Dh), 0, 2, 1, 3)
        scores = torch.einsum("bhqd,bhkd->bhqk", q, k_cache) * (Dh ** -0.5)
        p = _softmax(scores, axis=-1)
        o = torch.einsum("bhqk,bhkd->bhqd", p, v_cache)
        return (lambda x, *d: x.permute(*d))(o, 0, 2, 1, 3).reshape(B, Sq, H * Dh) @ wo

    a = _A_ref(A_x, A_k_cache, A_v_cache, A_wq, A_wo)
    b = _B_ref(B_x, B_k_cache, B_v_cache, B_wq, B_wo)
    return torch.concatenate([a, b], axis=-1)
```

```asm
; @launch grid=(256,1,1) block=(256,1,1) lds=20992
.amdgcn_target "amdgcn-amd-amdhsa--gfx950"
.text
.globl concat_heads__gqa_block_cached__mha_block_cached__decode_kernel
.p2align 8
.type concat_heads__gqa_block_cached__mha_block_cached__decode_kernel,@function
concat_heads__gqa_block_cached__mha_block_cached__decode_kernel:
  s_cmp_ge_u32 s2, 256
  s_cbranch_scc1 L_end
  s_load_dwordx16 s[4:19], s[0:1], 0
  s_load_dwordx8 s[20:27], s[0:1], 64
  s_load_dwordx2 s[28:29], s[0:1], 96
  s_getpc_b64 s[30:31]
L_pc:
  v_lshlrev_b32 v1, 6, v0
  v_min_u32 v1, L_end-L_pc, v1
  global_load_dword v23, v1, s[30:31]
  v_lshrrev_b32 v1, 6, v0
  v_and_b32 v0, 63, v0
  v_readfirstlane_b32 s62, v1
  s_lshr_b32 s60, s2, 5
  s_and_b32 s61, s2, 7
  s_lshl_b32 s61, s61, 2
  s_bfe_u32 s70, s2, 0x20003
  s_add_u32 s61, s61, s70
  s_lshr_b32 s63, s61, 3
  s_lshl_b32 s70, s60, 9
  s_and_b32 s71, s61, 15
  s_lshl_b32 s71, s71, 5
  s_add_u32 s65, s70, s71
  s_mul_i32 s72, s62, 112
  v_lshrrev_b32 v6, 2, v0
  v_add_u32 v6, s72, v6
  v_lshlrev_b32 v7, 1, v6
  v_lshlrev_b32 v6, 13, v6
  v_and_b32 v8, 3, v0
  v_lshl_add_u32 v6, v8, 4, v6
  v_and_b32 v3, 15, v0
  v_lshrrev_b32 v4, 4, v0
  v_lshlrev_b32 v1, 4, v4
  v_and_b32 v9, 1, v0
  v_lshl_add_u32 v1, v9, 6, v1
  v_bfe_u32 v9, v0, 1, 1
  v_lshl_add_u32 v1, v9, 10, v1
  v_bfe_u32 v9, v0, 2, 2
  v_lshl_add_u32 v1, v9, 12, v1
  v_lshlrev_b32 v2, 12, v4
  v_lshl_add_u32 v2, v3, 4, v2
  v_lshlrev_b32 v5, 4, v0
  s_bfe_u32 s31, s61, 0x20000
  s_lshl_b32 s31, s31, 15
  s_bfe_u32 s73, s61, 0x10002
  s_lshl_b32 s73, s73, 14
  s_or_b32 s31, s31, s73
  s_bfe_u32 s73, s61, 0x20003
  s_lshl_b32 s73, s73, 22
  s_or_b32 s31, s31, s73
  s_and_b32 s72, s62, 1
  s_lshl_b32 s72, s72, 21
  s_or_b32 s31, s31, s72
  s_mov_b32 s67, s31
  s_lshr_b32 s70, s61, 2
  s_lshl_b32 s70, s70, 1
  s_and_b32 s71, s61, 1
  s_or_b32 s70, s70, s71
  s_bfe_u32 s30, s70, 0x20000
  s_lshl_b32 s30, s30, 15
  s_bfe_u32 s73, s70, 0x10002
  s_lshl_b32 s73, s73, 14
  s_or_b32 s30, s30, s73
  s_bfe_u32 s73, s70, 0x10003
  s_lshl_b32 s73, s73, 23
  s_or_b32 s30, s30, s73
  s_or_b32 s30, s30, s72
  s_lshl_b32 s72, s60, 24
  s_lshl_b32 s73, s65, 1
  s_mov_b32 s42, 896
  s_mov_b32 s43, 0x20000
  s_mov_b32 s46, 3670016
  s_mov_b32 s47, 0x20000
  s_mov_b32 s34, 0x1000000
  s_mov_b32 s35, 0x20000
  s_mov_b32 s38, 0x1000000
  s_mov_b32 s39, 0x20000
  s_mov_b32 s50, 3670016
  s_mov_b32 s51, 0x20000
  s_mov_b32 s54, 1638400
  s_mov_b32 s55, 0x20000
  s_mov_b32 s58, 1792
  s_mov_b32 s59, 0x20000
  s_cmp_lt_u32 s63, 2
  s_waitcnt lgkmcnt(0)
  s_cselect_b32 s44, s10, s20
  s_cselect_b32 s45, s11, s21
  s_cselect_b32 s40, s4, s14
  s_cselect_b32 s41, s5, s15
  s_cselect_b32 s48, s12, s22
  s_cselect_b32 s49, s13, s23
  buffer_load_dwordx4 v[24:27], v6, s[44:47], s73 offen nt
  s_add_u32 s73, s73, 131072
  buffer_load_dwordx4 v[28:31], v6, s[44:47], s73 offen nt
  s_add_u32 s73, s73, 131072
  buffer_load_dwordx4 v[32:35], v6, s[44:47], s73 offen nt
  s_add_u32 s73, s73, 131072
  buffer_load_dwordx4 v[36:39], v6, s[44:47], s73 offen nt
  s_add_u32 s73, s73, 131072
  buffer_load_dwordx4 v[40:43], v6, s[44:47], s73 offen nt
  s_add_u32 s73, s73, 131072
  buffer_load_dwordx4 v[44:47], v6, s[44:47], s73 offen nt
  s_add_u32 s73, s73, 131072
  buffer_load_dwordx4 v[48:51], v6, s[44:47], s73 offen nt
  buffer_load_ushort v16, v7, s[40:43], 0 offen offset:0
  buffer_load_ushort v17, v7, s[40:43], 0 offen offset:32
  buffer_load_ushort v18, v7, s[40:43], 0 offen offset:64
  buffer_load_ushort v19, v7, s[40:43], 0 offen offset:96
  buffer_load_ushort v20, v7, s[40:43], 0 offen offset:128
  buffer_load_ushort v21, v7, s[40:43], 0 offen offset:160
  buffer_load_ushort v22, v7, s[40:43], 0 offen offset:192
  s_add_u32 s32, s6, s72
  s_addc_u32 s33, s7, 0
  s_add_u32 s36, s8, s72
  s_addc_u32 s37, s9, 0
  s_mov_b32 s52, s28
  s_mov_b32 s53, s29
  s_mov_b32 s56, s24
  s_mov_b32 s57, s25
  s_cmp_eq_u32 s62, 0
  s_cbranch_scc1 L_helper_pre
  s_barrier
  s_cmp_lg_u32 s62, 3
  s_cbranch_scc1 L_nw3
  s_load_dword s66, s[28:29], 0
  s_lshl_b32 s70, s60, 5
  s_add_u32 s70, s70, s61
  s_mul_i32 s69, s70, 6144
  s_add_u32 s69, s69, 65536
  s_branch L_wait0
L_nw3:
  buffer_load_dwordx4 v[64:67], v1, s[32:35], s67 offen offset:0 nt
  buffer_load_dwordx4 v[68:71], v1, s[32:35], s67 offen offset:128 nt
  buffer_load_dwordx4 v[72:75], v1, s[32:35], s67 offen offset:256 nt
  buffer_load_dwordx4 v[76:79], v1, s[32:35], s67 offen offset:384 nt
  buffer_load_dwordx4 v[80:83], v1, s[32:35], s67 offen offset:2048 nt
  buffer_load_dwordx4 v[84:87], v1, s[32:35], s67 offen offset:2176 nt
  buffer_load_dwordx4 v[88:91], v1, s[32:35], s67 offen offset:2304 nt
  buffer_load_dwordx4 v[92:95], v1, s[32:35], s67 offen offset:2432 nt
  s_waitcnt vmcnt(8)
  s_branch L_qpart
L_helper_pre:
  s_load_dword s66, s[28:29], 0
  v_mov_b32 v60, -1
  v_mov_b32 v61, -1
  v_mov_b32 v62, -1
  v_mov_b32 v63, -1
  s_lshl_b32 s70, s60, 5
  s_add_u32 s70, s70, s61
  s_mul_i32 s69, s70, 6144
  s_add_u32 s69, s69, 65536
  buffer_store_dwordx4 v[60:63], v5, s[52:55], s69 offen offset:0 sc1
  buffer_store_dwordx4 v[60:63], v5, s[52:55], s69 offen offset:1024 sc1
  buffer_store_dwordx4 v[60:63], v5, s[52:55], s69 offen offset:2048 sc1
  buffer_store_dwordx4 v[60:63], v5, s[52:55], s69 offen offset:3072 sc1
  s_add_u32 s70, s69, 4096
  buffer_store_dwordx4 v[60:63], v5, s[52:55], s70 offen offset:0 sc1
  buffer_store_dwordx4 v[60:63], v5, s[52:55], s70 offen offset:1024 sc1
  s_cmp_lg_u32 s61, 0
  s_cbranch_scc1 L_notz
  s_lshl_b32 s70, s60, 11
  s_add_u32 s70, s70, 40960
  s_mov_b64 exec, 31
  v_mov_b32 v59, 0
  v_lshlrev_b32 v58, 8, v0
  buffer_store_dword v59, v58, s[52:55], s70 offen sc1
  s_mov_b64 exec, -1
L_notz:
  s_barrier
L_wait0:
  s_waitcnt vmcnt(0)
L_qpart:
  v_lshlrev_b32 v16, 16, v16
  v_lshlrev_b32 v17, 16, v17
  v_lshlrev_b32 v18, 16, v18
  v_lshlrev_b32 v19, 16, v19
  v_lshlrev_b32 v20, 16, v20
  v_lshlrev_b32 v21, 16, v21
  v_lshlrev_b32 v22, 16, v22
  v_lshlrev_b32 v60, 16, v24
  v_and_b32 v61, 0xffff0000, v24
  v_mul_f32 v52, v60, v16
  v_mul_f32 v53, v61, v16
  v_lshlrev_b32 v60, 16, v25
  v_and_b32 v61, 0xffff0000, v25
  v_mul_f32 v54, v60, v16
  v_mul_f32 v55, v61, v16
  v_lshlrev_b32 v60, 16, v26
  v_and_b32 v61, 0xffff0000, v26
  v_mul_f32 v56, v60, v16
  v_mul_f32 v57, v61, v16
  v_lshlrev_b32 v60, 16, v27
  v_and_b32 v61, 0xffff0000, v27
  v_mul_f32 v58, v60, v16
  v_mul_f32 v59, v61, v16
  v_lshlrev_b32 v60, 16, v28
  v_and_b32 v61, 0xffff0000, v28
  v_fmac_f32 v52, v60, v17
  v_fmac_f32 v53, v61, v17
  v_lshlrev_b32 v60, 16, v29
  v_and_b32 v61, 0xffff0000, v29
  v_fmac_f32 v54, v60, v17
  v_fmac_f32 v55, v61, v17
  v_lshlrev_b32 v60, 16, v30
  v_and_b32 v61, 0xffff0000, v30
  v_fmac_f32 v56, v60, v17
  v_fmac_f32 v57, v61, v17
  v_lshlrev_b32 v60, 16, v31
  v_and_b32 v61, 0xffff0000, v31
  v_fmac_f32 v58, v60, v17
  v_fmac_f32 v59, v61, v17
  v_lshlrev_b32 v60, 16, v32
  v_and_b32 v61, 0xffff0000, v32
  v_fmac_f32 v52, v60, v18
  v_fmac_f32 v53, v61, v18
  v_lshlrev_b32 v60, 16, v33
  v_and_b32 v61, 0xffff0000, v33
  v_fmac_f32 v54, v60, v18
  v_fmac_f32 v55, v61, v18
  v_lshlrev_b32 v60, 16, v34
  v_and_b32 v61, 0xffff0000, v34
  v_fmac_f32 v56, v60, v18
  v_fmac_f32 v57, v61, v18
  v_lshlrev_b32 v60, 16, v35
  v_and_b32 v61, 0xffff0000, v35
  v_fmac_f32 v58, v60, v18
  v_fmac_f32 v59, v61, v18
  v_lshlrev_b32 v60, 16, v36
  v_and_b32 v61, 0xffff0000, v36
  v_fmac_f32 v52, v60, v19
  v_fmac_f32 v53, v61, v19
  v_lshlrev_b32 v60, 16, v37
  v_and_b32 v61, 0xffff0000, v37
  v_fmac_f32 v54, v60, v19
  v_fmac_f32 v55, v61, v19
  v_lshlrev_b32 v60, 16, v38
  v_and_b32 v61, 0xffff0000, v38
  v_fmac_f32 v56, v60, v19
  v_fmac_f32 v57, v61, v19
  v_lshlrev_b32 v60, 16, v39
  v_and_b32 v61, 0xffff0000, v39
  v_fmac_f32 v58, v60, v19
  v_fmac_f32 v59, v61, v19
  v_lshlrev_b32 v60, 16, v40
  v_and_b32 v61, 0xffff0000, v40
  v_fmac_f32 v52, v60, v20
  v_fmac_f32 v53, v61, v20
  v_lshlrev_b32 v60, 16, v41
  v_and_b32 v61, 0xffff0000, v41
  v_fmac_f32 v54, v60, v20
  v_fmac_f32 v55, v61, v20
  v_lshlrev_b32 v60, 16, v42
  v_and_b32 v61, 0xffff0000, v42
  v_fmac_f32 v56, v60, v20
  v_fmac_f32 v57, v61, v20
  v_lshlrev_b32 v60, 16, v43
  v_and_b32 v61, 0xffff0000, v43
  v_fmac_f32 v58, v60, v20
  v_fmac_f32 v59, v61, v20
  v_lshlrev_b32 v60, 16, v44
  v_and_b32 v61, 0xffff0000, v44
  v_fmac_f32 v52, v60, v21
  v_fmac_f32 v53, v61, v21
  v_lshlrev_b32 v60, 16, v45
  v_and_b32 v61, 0xffff0000, v45
  v_fmac_f32 v54, v60, v21
  v_fmac_f32 v55, v61, v21
  v_lshlrev_b32 v60, 16, v46
  v_and_b32 v61, 0xffff0000, v46
  v_fmac_f32 v56, v60, v21
  v_fmac_f32 v57, v61, v21
  v_lshlrev_b32 v60, 16, v47
  v_and_b32 v61, 0xffff0000, v47
  v_fmac_f32 v58, v60, v21
  v_fmac_f32 v59, v61, v21
  v_lshlrev_b32 v60, 16, v48
  v_and_b32 v61, 0xffff0000, v48
  v_fmac_f32 v52, v60, v22
  v_fmac_f32 v53, v61, v22
  v_lshlrev_b32 v60, 16, v49
  v_and_b32 v61, 0xffff0000, v49
  v_fmac_f32 v54, v60, v22
  v_fmac_f32 v55, v61, v22
  v_lshlrev_b32 v60, 16, v50
  v_and_b32 v61, 0xffff0000, v50
  v_fmac_f32 v56, v60, v22
  v_fmac_f32 v57, v61, v22
  v_lshlrev_b32 v60, 16, v51
  v_and_b32 v61, 0xffff0000, v51
  v_fmac_f32 v58, v60, v22
  v_fmac_f32 v59, v61, v22
  s_lshl_b32 s70, s62, 9
  v_lshlrev_b32 v60, 7, v4
  v_lshl_add_u32 v60, v8, 5, v60
  v_add_u32 v60, s70, v60
  v_add_f32_dpp v52, v52, v52 row_ror:4 row_mask:0xf bank_mask:0xf
  v_add_f32_dpp v53, v53, v53 row_ror:4 row_mask:0xf bank_mask:0xf
  v_add_f32_dpp v54, v54, v54 row_ror:4 row_mask:0xf bank_mask:0xf
  v_add_f32_dpp v55, v55, v55 row_ror:4 row_mask:0xf bank_mask:0xf
  v_add_f32_dpp v56, v56, v56 row_ror:4 row_mask:0xf bank_mask:0xf
  v_add_f32_dpp v57, v57, v57 row_ror:4 row_mask:0xf bank_mask:0xf
  v_add_f32_dpp v58, v58, v58 row_ror:4 row_mask:0xf bank_mask:0xf
  v_add_f32_dpp v59, v59, v59 row_ror:4 row_mask:0xf bank_mask:0xf
  v_add_f32_dpp v52, v52, v52 row_ror:8 row_mask:0xf bank_mask:0xf
  v_add_f32_dpp v53, v53, v53 row_ror:8 row_mask:0xf bank_mask:0xf
  v_add_f32_dpp v54, v54, v54 row_ror:8 row_mask:0xf bank_mask:0xf
  v_add_f32_dpp v55, v55, v55 row_ror:8 row_mask:0xf bank_mask:0xf
  v_add_f32_dpp v56, v56, v56 row_ror:8 row_mask:0xf bank_mask:0xf
  v_add_f32_dpp v57, v57, v57 row_ror:8 row_mask:0xf bank_mask:0xf
  v_add_f32_dpp v58, v58, v58 row_ror:8 row_mask:0xf bank_mask:0xf
  v_add_f32_dpp v59, v59, v59 row_ror:8 row_mask:0xf bank_mask:0xf
  s_mov_b32 exec_lo, 0x000f000f
  s_mov_b32 exec_hi, 0x000f000f
  ds_write_b128 v60, v[52:55] offset:2048
  ds_write_b128 v60, v[56:59] offset:2064
  s_mov_b64 exec, -1
  s_waitcnt lgkmcnt(0)
  s_barrier
  s_cmp_eq_u32 s62, 3
  s_cbranch_scc1 L_helper2
  s_cmp_lg_u32 s62, 0
  s_cbranch_scc1 L_stream
  v_and_b32 v60, 31, v0
  v_lshlrev_b32 v60, 2, v60
  v_lshrrev_b32 v61, 5, v0
  v_lshl_add_u32 v60, v61, 10, v60
  ds_read_b32 v16, v60 offset:2048
  ds_read_b32 v17, v60 offset:2176
  ds_read_b32 v18, v60 offset:2304
  ds_read_b32 v19, v60 offset:2432
  ds_read_b32 v20, v60 offset:2560
  ds_read_b32 v21, v60 offset:2688
  ds_read_b32 v22, v60 offset:2816
  ds_read_b32 v23, v60 offset:2944
  s_add_u32 s66, s66, 1640531527
  v_lshlrev_b32 v61, 2, v0
  s_lshl_b32 s70, s60, 12
  s_add_u32 s70, s70, 4096
  s_lshl_b32 s71, s61, 7
  s_add_u32 s71, s71, s70
  v_mov_b32 v25, s66
  s_waitcnt lgkmcnt(0)
  v_add_f32 v16, v16, v17
  v_add_f32 v18, v18, v19
  v_add_f32 v20, v20, v21
  v_add_f32 v22, v22, v23
  v_add_f32 v16, v16, v18
  v_add_f32 v20, v20, v22
  v_add_f32 v16, v16, v20
  v_mov_b32 v17, v16
  s_nop 1
  v_permlane32_swap_b32 v16, v17
  s_nop 0
  v_add_f32 v16, v16, v17
  s_nop 1
  v_mov_b32_dpp v17, v16 quad_perm:[1,0,3,2] row_mask:0xf bank_mask:0xf
  s_mov_b32 exec_lo, 0x55555555
  s_mov_b32 exec_hi, 0
  v_cvt_pk_bf16_f32 v24, v16, v17
  buffer_store_dwordx2 v[24:25], v61, s[52:55], s71 offen sc1
  s_mov_b64 exec, -1
  s_barrier
  s_mov_b32 s74, 200000
L_qpoll:
  buffer_load_dwordx4 v[16:19], v5, s[52:55], s70 offen offset:0 sc1
  buffer_load_dwordx4 v[20:23], v5, s[52:55], s70 offen offset:1024 sc1
  buffer_load_dwordx4 v[24:27], v5, s[52:55], s70 offen offset:2048 sc1
  buffer_load_dwordx4 v[28:31], v5, s[52:55], s70 offen offset:3072 sc1
  s_sub_u32 s74, s74, 1
  s_cbranch_scc1 L_qgot
  s_waitcnt vmcnt(0)
  v_xor_b32 v17, s66, v17
  v_xor_b32 v19, s66, v19
  v_xor_b32 v21, s66, v21
  v_xor_b32 v23, s66, v23
  v_xor_b32 v25, s66, v25
  v_xor_b32 v27, s66, v27
  v_xor_b32 v29, s66, v29
  v_xor_b32 v31, s66, v31
  v_or3_b32 v32, v17, v19, v21
  v_or3_b32 v33, v23, v25, v27
  v_or3_b32 v32, v32, v29, v31
  v_or_b32 v32, v32, v33
  v_cmp_ne_u32 vcc, 0, v32
  s_cbranch_vccnz L_qpoll
L_qgot:
  s_waitcnt vmcnt(0)
  v_lshlrev_b32 v60, 3, v0
  v_add_u32 v61, 1024, v60
  ds_write2_b32 v60, v16, v18 offset0:0 offset1:1
  ds_write2_b32 v60, v20, v22 offset0:128 offset1:129
  ds_write2_b32 v61, v24, v26 offset0:0 offset1:1
  ds_write2_b32 v61, v28, v30 offset0:128 offset1:129
  s_waitcnt lgkmcnt(0)
  s_barrier
  s_endpgm
L_stream:
  s_barrier
  buffer_load_dwordx4 v[96:99], v1, s[32:35], s67 offen offset:512 nt
  buffer_load_dwordx4 v[100:103], v1, s[32:35], s67 offen offset:640 nt
  buffer_load_dwordx4 v[104:107], v1, s[32:35], s67 offen offset:768 nt
  buffer_load_dwordx4 v[108:111], v1, s[32:35], s67 offen offset:896 nt
  buffer_load_dwordx4 v[112:115], v1, s[32:35], s67 offen offset:2560 nt
  buffer_load_dwordx4 v[116:119], v1, s[32:35], s67 offen offset:2688 nt
  buffer_load_dwordx4 v[120:123], v1, s[32:35], s67 offen offset:2816 nt
  buffer_load_dwordx4 v[124:127], v1, s[32:35], s67 offen offset:2944 nt
  s_or_b32 s67, s31, 131072
  buffer_load_dwordx4 v[128:131], v1, s[32:35], s67 offen offset:0 nt
  buffer_load_dwordx4 v[132:135], v1, s[32:35], s67 offen offset:128 nt
  buffer_load_dwordx4 v[136:139], v1, s[32:35], s67 offen offset:256 nt
  buffer_load_dwordx4 v[140:143], v1, s[32:35], s67 offen offset:384 nt
  buffer_load_dwordx4 v[144:147], v1, s[32:35], s67 offen offset:2048 nt
  buffer_load_dwordx4 v[148:151], v1, s[32:35], s67 offen offset:2176 nt
  buffer_load_dwordx4 v[152:155], v1, s[32:35], s67 offen offset:2304 nt
  buffer_load_dwordx4 v[156:159], v1, s[32:35], s67 offen offset:2432 nt
  buffer_load_dwordx4 v[160:163], v1, s[32:35], s67 offen offset:512 nt
  buffer_load_dwordx4 v[164:167], v1, s[32:35], s67 offen offset:640 nt
  buffer_load_dwordx4 v[168:171], v1, s[32:35], s67 offen offset:768 nt
  buffer_load_dwordx4 v[172:175], v1, s[32:35], s67 offen offset:896 nt
  buffer_load_dwordx4 v[176:179], v1, s[32:35], s67 offen offset:2560 nt
  buffer_load_dwordx4 v[180:183], v1, s[32:35], s67 offen offset:2688 nt
  buffer_load_dwordx4 v[184:187], v1, s[32:35], s67 offen offset:2816 nt
  buffer_load_dwordx4 v[188:191], v1, s[32:35], s67 offen offset:2944 nt
  s_or_b32 s67, s31, 262144
  buffer_load_dwordx4 v[192:195], v1, s[32:35], s67 offen offset:0 nt
  buffer_load_dwordx4 v[196:199], v1, s[32:35], s67 offen offset:128 nt
  buffer_load_dwordx4 v[200:203], v1, s[32:35], s67 offen offset:256 nt
  buffer_load_dwordx4 v[204:207], v1, s[32:35], s67 offen offset:384 nt
  buffer_load_dwordx4 v[208:211], v1, s[32:35], s67 offen offset:2048 nt
  buffer_load_dwordx4 v[212:215], v1, s[32:35], s67 offen offset:2176 nt
  buffer_load_dwordx4 v[216:219], v1, s[32:35], s67 offen offset:2304 nt
  buffer_load_dwordx4 v[220:223], v1, s[32:35], s67 offen offset:2432 nt
  buffer_load_dwordx4 v[224:227], v1, s[32:35], s67 offen offset:512 nt
  buffer_load_dwordx4 v[228:231], v1, s[32:35], s67 offen offset:640 nt
  buffer_load_dwordx4 v[232:235], v1, s[32:35], s67 offen offset:768 nt
  buffer_load_dwordx4 v[236:239], v1, s[32:35], s67 offen offset:896 nt
  buffer_load_dwordx4 v[240:243], v1, s[32:35], s67 offen offset:2560 nt
  buffer_load_dwordx4 v[244:247], v1, s[32:35], s67 offen offset:2688 nt
  buffer_load_dwordx4 v[248:251], v1, s[32:35], s67 offen offset:2816 nt
  buffer_load_dwordx4 v[252:255], v1, s[32:35], s67 offen offset:2944 nt
  v_and_b32 v60, 1, v0
  v_cmp_eq_u32 vcc, 1, v60
  v_mov_b32 v61, 0xffff
  v_mov_b32 v62, 0xffff0000
  v_bfe_u32 v60, v0, 1, 2
  v_cndmask_b32 v61, v61, v62, vcc
  v_cmp_eq_u32 vcc, 0, v60
  s_nop 1
  v_cndmask_b32 v8, 0, v61, vcc
  v_cmp_eq_u32 vcc, 1, v60
  s_nop 1
  v_cndmask_b32 v9, 0, v61, vcc
  v_cmp_eq_u32 vcc, 2, v60
  s_nop 1
  v_cndmask_b32 v10, 0, v61, vcc
  v_cmp_eq_u32 vcc, 3, v60
  s_nop 1
  v_cndmask_b32 v11, 0, v61, vcc
  v_mov_b32 v12, 0xfffffffe
  v_and_b32 v60, 1, v0
  v_lshlrev_b32 v60, 6, v60
  v_lshl_add_u32 v60, v4, 4, v60
  s_bfe_u32 s70, s61, 0x10001
  s_add_u32 s71, s70, 2
  s_lshl_b32 s71, s71, 9
  v_add_u32 v58, s71, v60
  v_bfe_u32 v61, v0, 3, 1
  v_lshl_add_u32 v63, v61, 9, v60
  s_and_b32 s71, s62, 1
  s_mul_i32 s72, s71, 6144
  s_add_u32 s72, s72, 4096
  v_lshlrev_b32 v59, 4, v4
  v_lshl_add_u32 v59, v61, 3, v59
  v_add_u32 v59, s72, v59
  v_mov_b32 v15, v59
  v_mov_b32 v6, 0xff7fffff
  v_mov_b32 v13, 0
  v_mov_b32 v16, 0
  v_mov_b32 v17, 0
  v_mov_b32 v18, 0
  v_mov_b32 v19, 0
  v_mov_b32 v20, 0
  v_mov_b32 v21, 0
  v_mov_b32 v22, 0
  v_mov_b32 v23, 0
  s_mov_b32 s69, 0x3db8aa3b
  s_mov_b32 s76, 0x01010101
  s_mov_b32 s77, 0x01010101
  s_mov_b32 s46, 0xaaaaaaaa
  s_mov_b32 s47, 0xaaaaaaaa
  s_lshl_b32 s66, s70, 8
  s_lshl_b32 s72, s60, 1
  s_add_u32 s70, s70, s72
  s_lshl_b32 s64, s70, 24
  s_lshl_b32 s70, s60, 11
  s_add_u32 s70, s70, 40960
  s_add_u32 s40, s28, s70
  s_addc_u32 s41, s29, 0
  s_lshl_b32 s70, s60, 5
  s_add_u32 s70, s70, s61
  s_mul_i32 s70, s70, 6144
  s_add_u32 s70, s70, 65536
  s_lshl_b32 s73, s71, 3
  s_add_u32 s73, s73, s70
  s_add_u32 s73, s73, 4112
  s_mul_i32 s72, s71, 2304
  s_add_u32 s72, s72, 16384
  s_lshl_b32 s71, s71, 10
  s_add_u32 s71, s71, s70
  s_add_u32 s71, s71, 2048
  v_lshrrev_b32 v14, 5, v0
  v_lshlrev_b32 v14, 10, v14
  v_lshl_add_u32 v14, v3, 5, v14
  v_bfe_u32 v60, v0, 4, 1
  v_lshl_add_u32 v14, v60, 4, v14
  s_mov_b32 s68, 3
  s_mov_b32 s43, 3
  s_mov_b32 s42, 0
  s_mov_b32 s44, 0
  s_mov_b32 s45, 0
  s_mov_b32 s74, 0
  s_mov_b32 s63, 0
  s_mov_b32 s75, 128
  s_mov_b32 s4, 0
  s_mov_b32 s5, 16
  s_mov_b32 s10, 0
  s_mov_b32 s11, 0
  s_mov_b32 s12, -1
  s_mov_b32 s13, -1
  s_mov_b32 s20, 0
  s_mov_b32 s21, 0
  s_mov_b32 s22, 0
  s_mov_b32 s75, -1
  v_mov_b32 v60, 0
  s_or_b32 s70, s31, 0
  v_writelane_b32 v60, s70, 0
  s_or_b32 s70, s31, 131072
  v_writelane_b32 v60, s70, 1
  s_or_b32 s70, s31, 262144
  v_writelane_b32 v60, s70, 2
  s_barrier
  ds_read_b128 v[24:27], v63 offset:0
  ds_read_b128 v[28:31], v63 offset:128
  ds_read_b128 v[32:35], v63 offset:256
  ds_read_b128 v[36:39], v63 offset:384
  s_waitcnt lgkmcnt(0)
L_top0:
  s_cmp_eq_u32 s45, 1
  s_cbranch_scc1 L_cv0
  s_cmp_eq_u32 s45, 2
  s_cbranch_scc1 L_cm0
  s_waitcnt vmcnt(32)
  v_mfma_f32_16x16x32_bf16 v[40:43], v[64:67], v[24:27], 0
  v_mfma_f32_16x16x32_bf16 v[44:47], v[80:83], v[24:27], 0
  v_mfma_f32_16x16x32_bf16 v[48:51], v[96:99], v[24:27], 0
  v_mfma_f32_16x16x32_bf16 v[52:55], v[112:115], v[24:27], 0
  v_mfma_f32_16x16x32_bf16 v[40:43], v[68:71], v[28:31], v[40:43]
  v_mfma_f32_16x16x32_bf16 v[44:47], v[84:87], v[28:31], v[44:47]
  v_mfma_f32_16x16x32_bf16 v[48:51], v[100:103], v[28:31], v[48:51]
  v_mfma_f32_16x16x32_bf16 v[52:55], v[116:119], v[28:31], v[52:55]
  v_mfma_f32_16x16x32_bf16 v[40:43], v[72:75], v[32:35], v[40:43]
  v_mfma_f32_16x16x32_bf16 v[44:47], v[88:91], v[32:35], v[44:47]
  v_mfma_f32_16x16x32_bf16 v[48:51], v[104:107], v[32:35], v[48:51]
  v_mfma_f32_16x16x32_bf16 v[52:55], v[120:123], v[32:35], v[52:55]
  v_mfma_f32_16x16x32_bf16 v[40:43], v[76:79], v[36:39], v[40:43]
  v_mfma_f32_16x16x32_bf16 v[44:47], v[92:95], v[36:39], v[44:47]
  v_mfma_f32_16x16x32_bf16 v[48:51], v[108:111], v[36:39], v[48:51]
  v_mfma_f32_16x16x32_bf16 v[52:55], v[124:127], v[36:39], v[52:55]
  s_nop 7
  v_cndmask_b32 v40, v40, v41, s[46:47]
  v_cndmask_b32 v42, v42, v43, s[46:47]
  v_cndmask_b32 v44, v44, v45, s[46:47]
  v_cndmask_b32 v46, v46, v47, s[46:47]
  v_cndmask_b32 v48, v48, v49, s[46:47]
  v_cndmask_b32 v50, v50, v51, s[46:47]
  v_cndmask_b32 v52, v52, v53, s[46:47]
  v_cndmask_b32 v54, v54, v55, s[46:47]
  v_add_f32_dpp v40, v40, v40 quad_perm:[1,0,3,2] row_mask:0xf bank_mask:0xf
  v_add_f32_dpp v42, v42, v42 quad_perm:[1,0,3,2] row_mask:0xf bank_mask:0xf
  v_add_f32_dpp v44, v44, v44 quad_perm:[1,0,3,2] row_mask:0xf bank_mask:0xf
  v_add_f32_dpp v46, v46, v46 quad_perm:[1,0,3,2] row_mask:0xf bank_mask:0xf
  v_add_f32_dpp v48, v48, v48 quad_perm:[1,0,3,2] row_mask:0xf bank_mask:0xf
  v_add_f32_dpp v50, v50, v50 quad_perm:[1,0,3,2] row_mask:0xf bank_mask:0xf
  v_add_f32_dpp v52, v52, v52 quad_perm:[1,0,3,2] row_mask:0xf bank_mask:0xf
  v_add_f32_dpp v54, v54, v54 quad_perm:[1,0,3,2] row_mask:0xf bank_mask:0xf
  v_max3_f32 v6, v6, v40, v42
  v_max3_f32 v6, v6, v44, v46
  v_cvt_pk_bf16_f32 v40, v40, v42
  v_cvt_pk_bf16_f32 v41, v44, v46
  v_max3_f32 v6, v6, v48, v50
  v_max3_f32 v6, v6, v52, v54
  v_cvt_pk_bf16_f32 v48, v48, v50
  v_cvt_pk_bf16_f32 v49, v52, v54
  s_mov_b64 exec, s[76:77]
  ds_write_b64 v15, v[40:41]
  ds_write_b64 v15, v[48:49] offset:64
  s_mov_b64 exec, -1
  v_add_u32 v15, 128, v15
  s_branch L_next0
L_cv0:
  ds_read_b64 v[40:41], v15
  ds_read_b64 v[42:43], v15 offset:64
  v_add_u32 v15, 128, v15
  s_cmp_lg_u32 s74, 0
  s_cbranch_scc1 L_dwv0
  s_waitcnt vmcnt(32)
L_dwbv0:
  s_waitcnt lgkmcnt(0)
  v_lshlrev_b32 v44, 16, v40
  v_and_b32 v45, 0xffff0000, v40
  v_lshlrev_b32 v46, 16, v41
  v_and_b32 v47, 0xffff0000, v41
  v_fma_f32 v48, v44, s69, -v7
  v_fma_f32 v49, v45, s69, -v7
  v_fma_f32 v50, v46, s69, -v7
  v_fma_f32 v51, v47, s69, -v7
  v_exp_f32 v48, v48
  v_exp_f32 v49, v49
  v_exp_f32 v50, v50
  v_exp_f32 v51, v51
  s_nop 0
  v_cvt_pk_bf16_f32 v52, v48, v48
  v_cvt_pk_bf16_f32 v53, v49, v49
  v_cvt_pk_bf16_f32 v54, v50, v50
  v_cvt_pk_bf16_f32 v55, v51, v51
  v_and_b32 v24, v52, v8
  v_and_b32 v25, v52, v9
  v_and_b32 v26, v52, v10
  v_and_b32 v27, v52, v11
  v_and_b32 v28, v53, v8
  v_and_b32 v29, v53, v9
  v_and_b32 v30, v53, v10
  v_and_b32 v31, v53, v11
  v_and_b32 v32, v54, v8
  v_and_b32 v33, v54, v9
  v_and_b32 v34, v54, v10
  v_and_b32 v35, v54, v11
  v_and_b32 v36, v55, v8
  v_and_b32 v37, v55, v9
  v_and_b32 v38, v55, v10
  v_and_b32 v39, v55, v11
  v_add_f32 v48, v48, v49
  v_add_f32 v50, v50, v51
  v_add_f32 v13, v13, v48
  v_add_f32 v13, v13, v50
  v_mfma_f32_16x16x32_bf16 v[16:19], v[24:27], v[64:67], v[16:19]
  v_mfma_f32_16x16x32_bf16 v[20:23], v[24:27], v[68:71], v[20:23]
  v_mfma_f32_16x16x32_bf16 v[16:19], v[28:31], v[72:75], v[16:19]
  v_mfma_f32_16x16x32_bf16 v[20:23], v[28:31], v[76:79], v[20:23]
  v_mfma_f32_16x16x32_bf16 v[16:19], v[32:35], v[80:83], v[16:19]
  v_mfma_f32_16x16x32_bf16 v[20:23], v[32:35], v[84:87], v[20:23]
  v_mfma_f32_16x16x32_bf16 v[16:19], v[36:39], v[88:91], v[16:19]
  v_mfma_f32_16x16x32_bf16 v[20:23], v[36:39], v[92:95], v[20:23]
  v_lshlrev_b32 v44, 16, v42
  v_and_b32 v45, 0xffff0000, v42
  v_lshlrev_b32 v46, 16, v43
  v_and_b32 v47, 0xffff0000, v43
  v_fma_f32 v48, v44, s69, -v7
  v_fma_f32 v49, v45, s69, -v7
  v_fma_f32 v50, v46, s69, -v7
  v_fma_f32 v51, v47, s69, -v7
  v_exp_f32 v48, v48
  v_exp_f32 v49, v49
  v_exp_f32 v50, v50
  v_exp_f32 v51, v51
  s_nop 0
  v_cvt_pk_bf16_f32 v52, v48, v48
  v_cvt_pk_bf16_f32 v53, v49, v49
  v_cvt_pk_bf16_f32 v54, v50, v50
  v_cvt_pk_bf16_f32 v55, v51, v51
  v_and_b32 v24, v52, v8
  v_and_b32 v25, v52, v9
  v_and_b32 v26, v52, v10
  v_and_b32 v27, v52, v11
  v_and_b32 v28, v53, v8
  v_and_b32 v29, v53, v9
  v_and_b32 v30, v53, v10
  v_and_b32 v31, v53, v11
  v_and_b32 v32, v54, v8
  v_and_b32 v33, v54, v9
  v_and_b32 v34, v54, v10
  v_and_b32 v35, v54, v11
  v_and_b32 v36, v55, v8
  v_and_b32 v37, v55, v9
  v_and_b32 v38, v55, v10
  v_and_b32 v39, v55, v11
  v_add_f32 v48, v48, v49
  v_add_f32 v50, v50, v51
  v_add_f32 v13, v13, v48
  v_add_f32 v13, v13, v50
  v_mfma_f32_16x16x32_bf16 v[16:19], v[24:27], v[96:99], v[16:19]
  v_mfma_f32_16x16x32_bf16 v[20:23], v[24:27], v[100:103], v[20:23]
  v_mfma_f32_16x16x32_bf16 v[16:19], v[28:31], v[104:107], v[16:19]
  v_mfma_f32_16x16x32_bf16 v[20:23], v[28:31], v[108:111], v[20:23]
  v_mfma_f32_16x16x32_bf16 v[16:19], v[32:35], v[112:115], v[16:19]
  v_mfma_f32_16x16x32_bf16 v[20:23], v[32:35], v[116:119], v[20:23]
  v_mfma_f32_16x16x32_bf16 v[16:19], v[36:39], v[120:123], v[16:19]
  v_mfma_f32_16x16x32_bf16 v[20:23], v[36:39], v[124:127], v[20:23]
  s_branch L_next0
L_cm0:
  s_waitcnt vmcnt(40)
  v_mfma_f32_16x16x32_bf16 v[40:43], v[64:67], v[24:27], 0
  v_mfma_f32_16x16x32_bf16 v[44:47], v[80:83], v[24:27], 0
  v_mfma_f32_16x16x32_bf16 v[40:43], v[68:71], v[28:31], v[40:43]
  v_mfma_f32_16x16x32_bf16 v[44:47], v[84:87], v[28:31], v[44:47]
  v_mfma_f32_16x16x32_bf16 v[40:43], v[72:75], v[32:35], v[40:43]
  v_mfma_f32_16x16x32_bf16 v[44:47], v[88:91], v[32:35], v[44:47]
  v_mfma_f32_16x16x32_bf16 v[40:43], v[76:79], v[36:39], v[40:43]
  v_mfma_f32_16x16x32_bf16 v[44:47], v[92:95], v[36:39], v[44:47]
  s_nop 7
  v_cndmask_b32 v40, v40, v41, s[46:47]
  v_cndmask_b32 v42, v42, v43, s[46:47]
  v_cndmask_b32 v44, v44, v45, s[46:47]
  v_cndmask_b32 v46, v46, v47, s[46:47]
  v_add_f32_dpp v40, v40, v40 quad_perm:[1,0,3,2] row_mask:0xf bank_mask:0xf
  v_add_f32_dpp v42, v42, v42 quad_perm:[1,0,3,2] row_mask:0xf bank_mask:0xf
  v_add_f32_dpp v44, v44, v44 quad_perm:[1,0,3,2] row_mask:0xf bank_mask:0xf
  v_add_f32_dpp v46, v46, v46 quad_perm:[1,0,3,2] row_mask:0xf bank_mask:0xf
  v_cvt_pk_bf16_f32 v56, v40, v42
  v_cvt_pk_bf16_f32 v57, v44, v46
  v_lshlrev_b32 v40, 16, v56
  v_and_b32 v42, 0xffff0000, v56
  v_lshlrev_b32 v44, 16, v57
  v_and_b32 v46, 0xffff0000, v57
  v_max3_f32 v56, v40, v42, v44
  v_max_f32 v56, v56, v46
  v_cmp_gt_f32 vcc, v56, v6
  s_cbranch_vccnz L_rare0
L_back0:
  v_fma_f32 v48, v40, s69, -v7
  v_fma_f32 v49, v42, s69, -v7
  v_fma_f32 v50, v44, s69, -v7
  v_fma_f32 v51, v46, s69, -v7
  v_exp_f32 v48, v48
  v_exp_f32 v49, v49
  v_exp_f32 v50, v50
  v_exp_f32 v51, v51
  s_nop 0
  v_cvt_pk_bf16_f32 v52, v48, v48
  v_cvt_pk_bf16_f32 v53, v49, v49
  v_cvt_pk_bf16_f32 v54, v50, v50
  v_cvt_pk_bf16_f32 v55, v51, v51
  v_and_b32 v64, v52, v8
  v_and_b32 v65, v52, v9
  v_and_b32 v66, v52, v10
  v_and_b32 v67, v52, v11
  v_and_b32 v68, v53, v8
  v_and_b32 v69, v53, v9
  v_and_b32 v70, v53, v10
  v_and_b32 v71, v53, v11
  v_and_b32 v72, v54, v8
  v_and_b32 v73, v54, v9
  v_and_b32 v74, v54, v10
  v_and_b32 v75, v54, v11
  v_and_b32 v76, v55, v8
  v_and_b32 v77, v55, v9
  v_and_b32 v78, v55, v10
  v_and_b32 v79, v55, v11
  v_add_f32 v48, v48, v49
  v_add_f32 v50, v50, v51
  v_add_f32 v13, v13, v48
  v_add_f32 v13, v13, v50
  s_cmp_lg_u32 s74, 0
  s_cbranch_scc1 L_dwm0
  s_waitcnt vmcnt(32)
L_dwbm0:
  v_mfma_f32_16x16x32_bf16 v[16:19], v[64:67], v[96:99], v[16:19]
  v_mfma_f32_16x16x32_bf16 v[20:23], v[64:67], v[100:103], v[20:23]
  v_mfma_f32_16x16x32_bf16 v[16:19], v[68:71], v[104:107], v[16:19]
  v_mfma_f32_16x16x32_bf16 v[20:23], v[68:71], v[108:111], v[20:23]
  v_mfma_f32_16x16x32_bf16 v[16:19], v[72:75], v[112:115], v[16:19]
  v_mfma_f32_16x16x32_bf16 v[20:23], v[72:75], v[116:119], v[20:23]
  v_mfma_f32_16x16x32_bf16 v[16:19], v[76:79], v[120:123], v[16:19]
  v_mfma_f32_16x16x32_bf16 v[20:23], v[76:79], v[124:127], v[20:23]
L_next0:
  s_add_u32 s42, s42, 1
  s_cmp_eq_u32 s42, s12
  s_cbranch_scc1 L_ctk0
  s_cmp_eq_u32 s42, s13
  s_cbranch_scc1 L_ctv0
L_ctb0:
  s_cmp_lg_u32 s74, 0
  s_cbranch_scc1 L_dn0
  s_cmp_eq_u32 s44, 2
  s_cbranch_scc1 L_im0
  s_cmp_eq_u32 s44, 1
  s_cbranch_scc1 L_iv0
L_ik0:
  s_cmp_ge_u32 s43, s5
  s_cbranch_scc1 L_ikt0
  s_mov_b32 s67, s31
  s_bfe_u32 s70, s43, 0x40000
  s_lshl_b32 s70, s70, 17
  s_or_b32 s67, s67, s70
  s_bfe_u32 s70, s43, 0x10004
  s_lshl_b32 s70, s70, 22
  s_or_b32 s67, s67, s70
L_ikg0:
  s_mov_b32 m0, s43
  s_add_u32 s43, s43, 1
  s_add_u32 s68, s68, 1
  v_writelane_b32 v60, s67, m0
  s_waitcnt vmcnt(12)
  buffer_load_dwordx4 v[64:67], v1, s[32:35], s67 offen offset:0 nt
  s_waitcnt vmcnt(12)
  buffer_load_dwordx4 v[68:71], v1, s[32:35], s67 offen offset:128 nt
  s_waitcnt vmcnt(12)
  buffer_load_dwordx4 v[72:75], v1, s[32:35], s67 offen offset:256 nt
  s_waitcnt vmcnt(12)
  buffer_load_dwordx4 v[76:79], v1, s[32:35], s67 offen offset:384 nt
  s_waitcnt vmcnt(12)
  buffer_load_dwordx4 v[80:83], v1, s[32:35], s67 offen offset:2048 nt
  s_waitcnt vmcnt(12)
  buffer_load_dwordx4 v[84:87], v1, s[32:35], s67 offen offset:2176 nt
  s_waitcnt vmcnt(12)
  buffer_load_dwordx4 v[88:91], v1, s[32:35], s67 offen offset:2304 nt
  s_waitcnt vmcnt(12)
  buffer_load_dwordx4 v[92:95], v1, s[32:35], s67 offen offset:2432 nt
  s_waitcnt vmcnt(12)
  buffer_load_dwordx4 v[96:99], v1, s[32:35], s67 offen offset:512 nt
  s_waitcnt vmcnt(12)
  buffer_load_dwordx4 v[100:103], v1, s[32:35], s67 offen offset:640 nt
  s_waitcnt vmcnt(12)
  buffer_load_dwordx4 v[104:107], v1, s[32:35], s67 offen offset:768 nt
  s_waitcnt vmcnt(12)
  buffer_load_dwordx4 v[108:111], v1, s[32:35], s67 offen offset:896 nt
  s_waitcnt vmcnt(12)
  buffer_load_dwordx4 v[112:115], v1, s[32:35], s67 offen offset:2560 nt
  s_waitcnt vmcnt(12)
  buffer_load_dwordx4 v[116:119], v1, s[32:35], s67 offen offset:2688 nt
  s_waitcnt vmcnt(12)
  buffer_load_dwordx4 v[120:123], v1, s[32:35], s67 offen offset:2816 nt
  s_waitcnt vmcnt(12)
  buffer_load_dwordx4 v[124:127], v1, s[32:35], s67 offen offset:2944 nt
  s_cmp_lt_u32 s43, s5
  s_cbranch_scc1 L_ikn0
  s_mov_b32 s75, -1
  s_cmp_ge_u32 s43, 48
  s_cbranch_scc1 L_ikn0
  s_cmp_eq_u32 s10, 0
  s_cbranch_scc1 L_ikn0
  s_mov_b32 s75, 1
  s_atomic_add s75, s[40:41], s21 glc
L_ikn0:
  s_cmp_eq_u32 s20, 0
  s_cbranch_scc1 L_top1
  s_mov_b32 s20, 0
  s_barrier
  s_branch L_top1
L_iv0:
  s_cmp_eq_u32 s43, s11
  s_cbranch_scc1 L_ive0
  v_readlane_b32 s67, v60, s43
  s_add_u32 s43, s43, 1
  s_add_u32 s68, s68, 1
  s_nop 3
  s_waitcnt vmcnt(12)
  buffer_load_dwordx4 v[64:67], v2, s[36:39], s67 offen offset:0 nt
  s_waitcnt vmcnt(12)
  buffer_load_dwordx4 v[68:71], v2, s[36:39], s67 offen offset:256 nt
  s_waitcnt vmcnt(12)
  buffer_load_dwordx4 v[72:75], v2, s[36:39], s67 offen offset:1024 nt
  s_waitcnt vmcnt(12)
  buffer_load_dwordx4 v[76:79], v2, s[36:39], s67 offen offset:1280 nt
  s_waitcnt vmcnt(12)
  buffer_load_dwordx4 v[80:83], v2, s[36:39], s67 offen offset:2048 nt
  s_waitcnt vmcnt(12)
  buffer_load_dwordx4 v[84:87], v2, s[36:39], s67 offen offset:2304 nt
  s_waitcnt vmcnt(12)
  buffer_load_dwordx4 v[88:91], v2, s[36:39], s67 offen offset:3072 nt
  s_waitcnt vmcnt(12)
  buffer_load_dwordx4 v[92:95], v2, s[36:39], s67 offen offset:3328 nt
  s_waitcnt vmcnt(12)
  buffer_load_dwordx4 v[96:99], v2, s[36:39], s67 offen offset:512 nt
  s_waitcnt vmcnt(12)
  buffer_load_dwordx4 v[100:103], v2, s[36:39], s67 offen offset:768 nt
  s_waitcnt vmcnt(12)
  buffer_load_dwordx4 v[104:107], v2, s[36:39], s67 offen offset:1536 nt
  s_waitcnt vmcnt(12)
  buffer_load_dwordx4 v[108:111], v2, s[36:39], s67 offen offset:1792 nt
  s_waitcnt vmcnt(12)
  buffer_load_dwordx4 v[112:115], v2, s[36:39], s67 offen offset:2560 nt
  s_waitcnt vmcnt(12)
  buffer_load_dwordx4 v[116:119], v2, s[36:39], s67 offen offset:2816 nt
  s_waitcnt vmcnt(12)
  buffer_load_dwordx4 v[120:123], v2, s[36:39], s67 offen offset:3584 nt
  s_waitcnt vmcnt(12)
  buffer_load_dwordx4 v[124:127], v2, s[36:39], s67 offen offset:3840 nt
  s_cmp_lg_u32 s43, s11
  s_cbranch_scc1 L_top1
  s_cmp_eq_u32 s4, 0
  s_cbranch_scc1 L_top1
  s_add_u32 s21, s66, 768
  s_mov_b32 s75, -1
  s_branch L_tk0
L_im0:
  s_waitcnt lgkmcnt(0)
  s_cmp_ge_u32 s75, 128
  s_cbranch_scc1 L_dn0
  s_bfe_u32 s67, s75, 0x20000
  s_lshl_b32 s67, s67, 15
  s_bfe_u32 s70, s75, 0x10002
  s_lshl_b32 s70, s70, 14
  s_or_b32 s67, s67, s70
  s_bfe_u32 s70, s75, 0x10003
  s_lshl_b32 s70, s70, 23
  s_or_b32 s67, s67, s70
  s_bfe_u32 s70, s75, 0x10004
  s_lshl_b32 s70, s70, 21
  s_or_b32 s67, s67, s70
  s_lshr_b32 s75, s75, 5
  s_and_b32 s70, s75, 1
  s_lshl_b32 s70, s70, 9
  s_or_b32 s67, s67, s70
  s_lshr_b32 s75, s75, 1
  s_add_u32 s75, s75, 30
  s_bfe_u32 s70, s75, 0x40000
  s_lshl_b32 s70, s70, 17
  s_or_b32 s67, s67, s70
  s_bfe_u32 s70, s75, 0x10004
  s_lshl_b32 s70, s70, 22
  s_or_b32 s67, s67, s70
L_imi0:
  s_waitcnt vmcnt(4)
  buffer_load_dwordx4 v[64:67], v1, s[32:35], s67 offen offset:0 nt
  buffer_load_dwordx4 v[68:71], v1, s[32:35], s67 offen offset:128 nt
  buffer_load_dwordx4 v[72:75], v1, s[32:35], s67 offen offset:256 nt
  buffer_load_dwordx4 v[76:79], v1, s[32:35], s67 offen offset:384 nt
  buffer_load_dwordx4 v[80:83], v1, s[32:35], s67 offen offset:2048 nt
  buffer_load_dwordx4 v[84:87], v1, s[32:35], s67 offen offset:2176 nt
  buffer_load_dwordx4 v[88:91], v1, s[32:35], s67 offen offset:2304 nt
  buffer_load_dwordx4 v[92:95], v1, s[32:35], s67 offen offset:2432 nt
  buffer_load_dwordx4 v[96:99], v2, s[36:39], s67 offen offset:0 nt
  buffer_load_dwordx4 v[100:103], v2, s[36:39], s67 offen offset:256 nt
  buffer_load_dwordx4 v[104:107], v2, s[36:39], s67 offen offset:1024 nt
  buffer_load_dwordx4 v[108:111], v2, s[36:39], s67 offen offset:1280 nt
  buffer_load_dwordx4 v[112:115], v2, s[36:39], s67 offen offset:2048 nt
  buffer_load_dwordx4 v[116:119], v2, s[36:39], s67 offen offset:2304 nt
  buffer_load_dwordx4 v[120:123], v2, s[36:39], s67 offen offset:3072 nt
  buffer_load_dwordx4 v[124:127], v2, s[36:39], s67 offen offset:3328 nt
L_tk0:
  s_mov_b32 s75, 1
  s_atomic_add s75, s[40:41], s21 glc
L_top1:
  s_cmp_eq_u32 s45, 1
  s_cbranch_scc1 L_cv1
  s_cmp_eq_u32 s45, 2
  s_cbranch_scc1 L_cm1
  s_waitcnt vmcnt(32)
  v_mfma_f32_16x16x32_bf16 v[40:43], v[128:131], v[24:27], 0
  v_mfma_f32_16x16x32_bf16 v[44:47], v[144:147], v[24:27], 0
  v_mfma_f32_16x16x32_bf16 v[48:51], v[160:163], v[24:27], 0
  v_mfma_f32_16x16x32_bf16 v[52:55], v[176:179], v[24:27], 0
  v_mfma_f32_16x16x32_bf16 v[40:43], v[132:135], v[28:31], v[40:43]
  v_mfma_f32_16x16x32_bf16 v[44:47], v[148:151], v[28:31], v[44:47]
  v_mfma_f32_16x16x32_bf16 v[48:51], v[164:167], v[28:31], v[48:51]
  v_mfma_f32_16x16x32_bf16 v[52:55], v[180:183], v[28:31], v[52:55]
  v_mfma_f32_16x16x32_bf16 v[40:43], v[136:139], v[32:35], v[40:43]
  v_mfma_f32_16x16x32_bf16 v[44:47], v[152:155], v[32:35], v[44:47]
  v_mfma_f32_16x16x32_bf16 v[48:51], v[168:171], v[32:35], v[48:51]
  v_mfma_f32_16x16x32_bf16 v[52:55], v[184:187], v[32:35], v[52:55]
  v_mfma_f32_16x16x32_bf16 v[40:43], v[140:143], v[36:39], v[40:43]
  v_mfma_f32_16x16x32_bf16 v[44:47], v[156:159], v[36:39], v[44:47]
  v_mfma_f32_16x16x32_bf16 v[48:51], v[172:175], v[36:39], v[48:51]
  v_mfma_f32_16x16x32_bf16 v[52:55], v[188:191], v[36:39], v[52:55]
  s_nop 7
  v_cndmask_b32 v40, v40, v41, s[46:47]
  v_cndmask_b32 v42, v42, v43, s[46:47]
  v_cndmask_b32 v44, v44, v45, s[46:47]
  v_cndmask_b32 v46, v46, v47, s[46:47]
  v_cndmask_b32 v48, v48, v49, s[46:47]
  v_cndmask_b32 v50, v50, v51, s[46:47]
  v_cndmask_b32 v52, v52, v53, s[46:47]
  v_cndmask_b32 v54, v54, v55, s[46:47]
  v_add_f32_dpp v40, v40, v40 quad_perm:[1,0,3,2] row_mask:0xf bank_mask:0xf
  v_add_f32_dpp v42, v42, v42 quad_perm:[1,0,3,2] row_mask:0xf bank_mask:0xf
  v_add_f32_dpp v44, v44, v44 quad_perm:[1,0,3,2] row_mask:0xf bank_mask:0xf
  v_add_f32_dpp v46, v46, v46 quad_perm:[1,0,3,2] row_mask:0xf bank_mask:0xf
  v_add_f32_dpp v48, v48, v48 quad_perm:[1,0,3,2] row_mask:0xf bank_mask:0xf
  v_add_f32_dpp v50, v50, v50 quad_perm:[1,0,3,2] row_mask:0xf bank_mask:0xf
  v_add_f32_dpp v52, v52, v52 quad_perm:[1,0,3,2] row_mask:0xf bank_mask:0xf
  v_add_f32_dpp v54, v54, v54 quad_perm:[1,0,3,2] row_mask:0xf bank_mask:0xf
  v_max3_f32 v6, v6, v40, v42
  v_max3_f32 v6, v6, v44, v46
  v_cvt_pk_bf16_f32 v40, v40, v42
  v_cvt_pk_bf16_f32 v41, v44, v46
  v_max3_f32 v6, v6, v48, v50
  v_max3_f32 v6, v6, v52, v54
  v_cvt_pk_bf16_f32 v48, v48, v50
  v_cvt_pk_bf16_f32 v49, v52, v54
  s_mov_b64 exec, s[76:77]
  ds_write_b64 v15, v[40:41]
  ds_write_b64 v15, v[48:49] offset:64
  s_mov_b64 exec, -1
  v_add_u32 v15, 128, v15
  s_branch L_next1
L_cv1:
  ds_read_b64 v[40:41], v15
  ds_read_b64 v[42:43], v15 offset:64
  v_add_u32 v15, 128, v15
  s_cmp_lg_u32 s74, 0
  s_cbranch_scc1 L_dwv1
  s_waitcnt vmcnt(32)
L_dwbv1:
  s_waitcnt lgkmcnt(0)
  v_lshlrev_b32 v44, 16, v40
  v_and_b32 v45, 0xffff0000, v40
  v_lshlrev_b32 v46, 16, v41
  v_and_b32 v47, 0xffff0000, v41
  v_fma_f32 v48, v44, s69, -v7
  v_fma_f32 v49, v45, s69, -v7
  v_fma_f32 v50, v46, s69, -v7
  v_fma_f32 v51, v47, s69, -v7
  v_exp_f32 v48, v48
  v_exp_f32 v49, v49
  v_exp_f32 v50, v50
  v_exp_f32 v51, v51
  s_nop 0
  v_cvt_pk_bf16_f32 v52, v48, v48
  v_cvt_pk_bf16_f32 v53, v49, v49
  v_cvt_pk_bf16_f32 v54, v50, v50
  v_cvt_pk_bf16_f32 v55, v51, v51
  v_and_b32 v24, v52, v8
  v_and_b32 v25, v52, v9
  v_and_b32 v26, v52, v10
  v_and_b32 v27, v52, v11
  v_and_b32 v28, v53, v8
  v_and_b32 v29, v53, v9
  v_and_b32 v30, v53, v10
  v_and_b32 v31, v53, v11
  v_and_b32 v32, v54, v8
  v_and_b32 v33, v54, v9
  v_and_b32 v34, v54, v10
  v_and_b32 v35, v54, v11
  v_and_b32 v36, v55, v8
  v_and_b32 v37, v55, v9
  v_and_b32 v38, v55, v10
  v_and_b32 v39, v55, v11
  v_add_f32 v48, v48, v49
  v_add_f32 v50, v50, v51
  v_add_f32 v13, v13, v48
  v_add_f32 v13, v13, v50
  v_mfma_f32_16x16x32_bf16 v[16:19], v[24:27], v[128:131], v[16:19]
  v_mfma_f32_16x16x32_bf16 v[20:23], v[24:27], v[132:135], v[20:23]
  v_mfma_f32_16x16x32_bf16 v[16:19], v[28:31], v[136:139], v[16:19]
  v_mfma_f32_16x16x32_bf16 v[20:23], v[28:31], v[140:143], v[20:23]
  v_mfma_f32_16x16x32_bf16 v[16:19], v[32:35], v[144:147], v[16:19]
  v_mfma_f32_16x16x32_bf16 v[20:23], v[32:35], v[148:151], v[20:23]
  v_mfma_f32_16x16x32_bf16 v[16:19], v[36:39], v[152:155], v[16:19]
  v_mfma_f32_16x16x32_bf16 v[20:23], v[36:39], v[156:159], v[20:23]
  v_lshlrev_b32 v44, 16, v42
  v_and_b32 v45, 0xffff0000, v42
  v_lshlrev_b32 v46, 16, v43
  v_and_b32 v47, 0xffff0000, v43
  v_fma_f32 v48, v44, s69, -v7
  v_fma_f32 v49, v45, s69, -v7
  v_fma_f32 v50, v46, s69, -v7
  v_fma_f32 v51, v47, s69, -v7
  v_exp_f32 v48, v48
  v_exp_f32 v49, v49
  v_exp_f32 v50, v50
  v_exp_f32 v51, v51
  s_nop 0
  v_cvt_pk_bf16_f32 v52, v48, v48
  v_cvt_pk_bf16_f32 v53, v49, v49
  v_cvt_pk_bf16_f32 v54, v50, v50
  v_cvt_pk_bf16_f32 v55, v51, v51
  v_and_b32 v24, v52, v8
  v_and_b32 v25, v52, v9
  v_and_b32 v26, v52, v10
  v_and_b32 v27, v52, v11
  v_and_b32 v28, v53, v8
  v_and_b32 v29, v53, v9
  v_and_b32 v30, v53, v10
  v_and_b32 v31, v53, v11
  v_and_b32 v32, v54, v8
  v_and_b32 v33, v54, v9
  v_and_b32 v34, v54, v10
  v_and_b32 v35, v54, v11
  v_and_b32 v36, v55, v8
  v_and_b32 v37, v55, v9
  v_and_b32 v38, v55, v10
  v_and_b32 v39, v55, v11
  v_add_f32 v48, v48, v49
  v_add_f32 v50, v50, v51
  v_add_f32 v13, v13, v48
  v_add_f32 v13, v13, v50
  v_mfma_f32_16x16x32_bf16 v[16:19], v[24:27], v[160:163], v[16:19]
  v_mfma_f32_16x16x32_bf16 v[20:23], v[24:27], v[164:167], v[20:23]
  v_mfma_f32_16x16x32_bf16 v[16:19], v[28:31], v[168:171], v[16:19]
  v_mfma_f32_16x16x32_bf16 v[20:23], v[28:31], v[172:175], v[20:23]
  v_mfma_f32_16x16x32_bf16 v[16:19], v[32:35], v[176:179], v[16:19]
  v_mfma_f32_16x16x32_bf16 v[20:23], v[32:35], v[180:183], v[20:23]
  v_mfma_f32_16x16x32_bf16 v[16:19], v[36:39], v[184:187], v[16:19]
  v_mfma_f32_16x16x32_bf16 v[20:23], v[36:39], v[188:191], v[20:23]
  s_branch L_next1
L_cm1:
  s_waitcnt vmcnt(40)
  v_mfma_f32_16x16x32_bf16 v[40:43], v[128:131], v[24:27], 0
  v_mfma_f32_16x16x32_bf16 v[44:47], v[144:147], v[24:27], 0
  v_mfma_f32_16x16x32_bf16 v[40:43], v[132:135], v[28:31], v[40:43]
  v_mfma_f32_16x16x32_bf16 v[44:47], v[148:151], v[28:31], v[44:47]
  v_mfma_f32_16x16x32_bf16 v[40:43], v[136:139], v[32:35], v[40:43]
  v_mfma_f32_16x16x32_bf16 v[44:47], v[152:155], v[32:35], v[44:47]
  v_mfma_f32_16x16x32_bf16 v[40:43], v[140:143], v[36:39], v[40:43]
  v_mfma_f32_16x16x32_bf16 v[44:47], v[156:159], v[36:39], v[44:47]
  s_nop 7
  v_cndmask_b32 v40, v40, v41, s[46:47]
  v_cndmask_b32 v42, v42, v43, s[46:47]
  v_cndmask_b32 v44, v44, v45, s[46:47]
  v_cndmask_b32 v46, v46, v47, s[46:47]
  v_add_f32_dpp v40, v40, v40 quad_perm:[1,0,3,2] row_mask:0xf bank_mask:0xf
  v_add_f32_dpp v42, v42, v42 quad_perm:[1,0,3,2] row_mask:0xf bank_mask:0xf
  v_add_f32_dpp v44, v44, v44 quad_perm:[1,0,3,2] row_mask:0xf bank_mask:0xf
  v_add_f32_dpp v46, v46, v46 quad_perm:[1,0,3,2] row_mask:0xf bank_mask:0xf
  v_cvt_pk_bf16_f32 v56, v40, v42
  v_cvt_pk_bf16_f32 v57, v44, v46
  v_lshlrev_b32 v40, 16, v56
  v_and_b32 v42, 0xffff0000, v56
  v_lshlrev_b32 v44, 16, v57
  v_and_b32 v46, 0xffff0000, v57
  v_max3_f32 v56, v40, v42, v44
  v_max_f32 v56, v56, v46
  v_cmp_gt_f32 vcc, v56, v6
  s_cbranch_vccnz L_rare1
L_back1:
  v_fma_f32 v48, v40, s69, -v7
  v_fma_f32 v49, v42, s69, -v7
  v_fma_f32 v50, v44, s69, -v7
  v_fma_f32 v51, v46, s69, -v7
  v_exp_f32 v48, v48
  v_exp_f32 v49, v49
  v_exp_f32 v50, v50
  v_exp_f32 v51, v51
  s_nop 0
  v_cvt_pk_bf16_f32 v52, v48, v48
  v_cvt_pk_bf16_f32 v53, v49, v49
  v_cvt_pk_bf16_f32 v54, v50, v50
  v_cvt_pk_bf16_f32 v55, v51, v51
  v_and_b32 v128, v52, v8
  v_and_b32 v129, v52, v9
  v_and_b32 v130, v52, v10
  v_and_b32 v131, v52, v11
  v_and_b32 v132, v53, v8
  v_and_b32 v133, v53, v9
  v_and_b32 v134, v53, v10
  v_and_b32 v135, v53, v11
  v_and_b32 v136, v54, v8
  v_and_b32 v137, v54, v9
  v_and_b32 v138, v54, v10
  v_and_b32 v139, v54, v11
  v_and_b32 v140, v55, v8
  v_and_b32 v141, v55, v9
  v_and_b32 v142, v55, v10
  v_and_b32 v143, v55, v11
  v_add_f32 v48, v48, v49
  v_add_f32 v50, v50, v51
  v_add_f32 v13, v13, v48
  v_add_f32 v13, v13, v50
  s_cmp_lg_u32 s74, 0
  s_cbranch_scc1 L_dwm1
  s_waitcnt vmcnt(32)
L_dwbm1:
  v_mfma_f32_16x16x32_bf16 v[16:19], v[128:131], v[160:163], v[16:19]
  v_mfma_f32_16x16x32_bf16 v[20:23], v[128:131], v[164:167], v[20:23]
  v_mfma_f32_16x16x32_bf16 v[16:19], v[132:135], v[168:171], v[16:19]
  v_mfma_f32_16x16x32_bf16 v[20:23], v[132:135], v[172:175], v[20:23]
  v_mfma_f32_16x16x32_bf16 v[16:19], v[136:139], v[176:179], v[16:19]
  v_mfma_f32_16x16x32_bf16 v[20:23], v[136:139], v[180:183], v[20:23]
  v_mfma_f32_16x16x32_bf16 v[16:19], v[140:143], v[184:187], v[16:19]
  v_mfma_f32_16x16x32_bf16 v[20:23], v[140:143], v[188:191], v[20:23]
L_next1:
  s_add_u32 s42, s42, 1
  s_cmp_eq_u32 s42, s12
  s_cbranch_scc1 L_ctk1
  s_cmp_eq_u32 s42, s13
  s_cbranch_scc1 L_ctv1
L_ctb1:
  s_cmp_lg_u32 s74, 0
  s_cbranch_scc1 L_dn1
  s_cmp_eq_u32 s44, 2
  s_cbranch_scc1 L_im1
  s_cmp_eq_u32 s44, 1
  s_cbranch_scc1 L_iv1
L_ik1:
  s_cmp_ge_u32 s43, s5
  s_cbranch_scc1 L_ikt1
  s_mov_b32 s67, s31
  s_bfe_u32 s70, s43, 0x40000
  s_lshl_b32 s70, s70, 17
  s_or_b32 s67, s67, s70
  s_bfe_u32 s70, s43, 0x10004
  s_lshl_b32 s70, s70, 22
  s_or_b32 s67, s67, s70
L_ikg1:
  s_mov_b32 m0, s43
  s_add_u32 s43, s43, 1
  s_add_u32 s68, s68, 1
  v_writelane_b32 v60, s67, m0
  s_waitcnt vmcnt(12)
  buffer_load_dwordx4 v[128:131], v1, s[32:35], s67 offen offset:0 nt
  s_waitcnt vmcnt(12)
  buffer_load_dwordx4 v[132:135], v1, s[32:35], s67 offen offset:128 nt
  s_waitcnt vmcnt(12)
  buffer_load_dwordx4 v[136:139], v1, s[32:35], s67 offen offset:256 nt
  s_waitcnt vmcnt(12)
  buffer_load_dwordx4 v[140:143], v1, s[32:35], s67 offen offset:384 nt
  s_waitcnt vmcnt(12)
  buffer_load_dwordx4 v[144:147], v1, s[32:35], s67 offen offset:2048 nt
  s_waitcnt vmcnt(12)
  buffer_load_dwordx4 v[148:151], v1, s[32:35], s67 offen offset:2176 nt
  s_waitcnt vmcnt(12)
  buffer_load_dwordx4 v[152:155], v1, s[32:35], s67 offen offset:2304 nt
  s_waitcnt vmcnt(12)
  buffer_load_dwordx4 v[156:159], v1, s[32:35], s67 offen offset:2432 nt
  s_waitcnt vmcnt(12)
  buffer_load_dwordx4 v[160:163], v1, s[32:35], s67 offen offset:512 nt
  s_waitcnt vmcnt(12)
  buffer_load_dwordx4 v[164:167], v1, s[32:35], s67 offen offset:640 nt
  s_waitcnt vmcnt(12)
  buffer_load_dwordx4 v[168:171], v1, s[32:35], s67 offen offset:768 nt
  s_waitcnt vmcnt(12)
  buffer_load_dwordx4 v[172:175], v1, s[32:35], s67 offen offset:896 nt
  s_waitcnt vmcnt(12)
  buffer_load_dwordx4 v[176:179], v1, s[32:35], s67 offen offset:2560 nt
  s_waitcnt vmcnt(12)
  buffer_load_dwordx4 v[180:183], v1, s[32:35], s67 offen offset:2688 nt
  s_waitcnt vmcnt(12)
  buffer_load_dwordx4 v[184:187], v1, s[32:35], s67 offen offset:2816 nt
  s_waitcnt vmcnt(12)
  buffer_load_dwordx4 v[188:191], v1, s[32:35], s67 offen offset:2944 nt
  s_cmp_lt_u32 s43, s5
  s_cbranch_scc1 L_ikn1
  s_mov_b32 s75, -1
  s_cmp_ge_u32 s43, 48
  s_cbranch_scc1 L_ikn1
  s_cmp_eq_u32 s10, 0
  s_cbranch_scc1 L_ikn1
  s_mov_b32 s75, 1
  s_atomic_add s75, s[40:41], s21 glc
L_ikn1:
  s_cmp_eq_u32 s20, 0
  s_cbranch_scc1 L_top2
  s_mov_b32 s20, 0
  s_barrier
  s_branch L_top2
L_iv1:
  s_cmp_eq_u32 s43, s11
  s_cbranch_scc1 L_ive1
  v_readlane_b32 s67, v60, s43
  s_add_u32 s43, s43, 1
  s_add_u32 s68, s68, 1
  s_nop 3
  s_waitcnt vmcnt(12)
  buffer_load_dwordx4 v[128:131], v2, s[36:39], s67 offen offset:0 nt
  s_waitcnt vmcnt(12)
  buffer_load_dwordx4 v[132:135], v2, s[36:39], s67 offen offset:256 nt
  s_waitcnt vmcnt(12)
  buffer_load_dwordx4 v[136:139], v2, s[36:39], s67 offen offset:1024 nt
  s_waitcnt vmcnt(12)
  buffer_load_dwordx4 v[140:143], v2, s[36:39], s67 offen offset:1280 nt
  s_waitcnt vmcnt(12)
  buffer_load_dwordx4 v[144:147], v2, s[36:39], s67 offen offset:2048 nt
  s_waitcnt vmcnt(12)
  buffer_load_dwordx4 v[148:151], v2, s[36:39], s67 offen offset:2304 nt
  s_waitcnt vmcnt(12)
  buffer_load_dwordx4 v[152:155], v2, s[36:39], s67 offen offset:3072 nt
  s_waitcnt vmcnt(12)
  buffer_load_dwordx4 v[156:159], v2, s[36:39], s67 offen offset:3328 nt
  s_waitcnt vmcnt(12)
  buffer_load_dwordx4 v[160:163], v2, s[36:39], s67 offen offset:512 nt
  s_waitcnt vmcnt(12)
  buffer_load_dwordx4 v[164:167], v2, s[36:39], s67 offen offset:768 nt
  s_waitcnt vmcnt(12)
  buffer_load_dwordx4 v[168:171], v2, s[36:39], s67 offen offset:1536 nt
  s_waitcnt vmcnt(12)
  buffer_load_dwordx4 v[172:175], v2, s[36:39], s67 offen offset:1792 nt
  s_waitcnt vmcnt(12)
  buffer_load_dwordx4 v[176:179], v2, s[36:39], s67 offen offset:2560 nt
  s_waitcnt vmcnt(12)
  buffer_load_dwordx4 v[180:183], v2, s[36:39], s67 offen offset:2816 nt
  s_waitcnt vmcnt(12)
  buffer_load_dwordx4 v[184:187], v2, s[36:39], s67 offen offset:3584 nt
  s_waitcnt vmcnt(12)
  buffer_load_dwordx4 v[188:191], v2, s[36:39], s67 offen offset:3840 nt
  s_cmp_lg_u32 s43, s11
  s_cbranch_scc1 L_top2
  s_cmp_eq_u32 s4, 0
  s_cbranch_scc1 L_top2
  s_add_u32 s21, s66, 768
  s_mov_b32 s75, -1
  s_branch L_tk1
L_im1:
  s_waitcnt lgkmcnt(0)
  s_cmp_ge_u32 s75, 128
  s_cbranch_scc1 L_dn1
  s_bfe_u32 s67, s75, 0x20000
  s_lshl_b32 s67, s67, 15
  s_bfe_u32 s70, s75, 0x10002
  s_lshl_b32 s70, s70, 14
  s_or_b32 s67, s67, s70
  s_bfe_u32 s70, s75, 0x10003
  s_lshl_b32 s70, s70, 23
  s_or_b32 s67, s67, s70
  s_bfe_u32 s70, s75, 0x10004
  s_lshl_b32 s70, s70, 21
  s_or_b32 s67, s67, s70
  s_lshr_b32 s75, s75, 5
  s_and_b32 s70, s75, 1
  s_lshl_b32 s70, s70, 9
  s_or_b32 s67, s67, s70
  s_lshr_b32 s75, s75, 1
  s_add_u32 s75, s75, 30
  s_bfe_u32 s70, s75, 0x40000
  s_lshl_b32 s70, s70, 17
  s_or_b32 s67, s67, s70
  s_bfe_u32 s70, s75, 0x10004
  s_lshl_b32 s70, s70, 22
  s_or_b32 s67, s67, s70
L_imi1:
  s_waitcnt vmcnt(4)
  buffer_load_dwordx4 v[128:131], v1, s[32:35], s67 offen offset:0 nt
  buffer_load_dwordx4 v[132:135], v1, s[32:35], s67 offen offset:128 nt
  buffer_load_dwordx4 v[136:139], v1, s[32:35], s67 offen offset:256 nt
  buffer_load_dwordx4 v[140:143], v1, s[32:35], s67 offen offset:384 nt
  buffer_load_dwordx4 v[144:147], v1, s[32:35], s67 offen offset:2048 nt
  buffer_load_dwordx4 v[148:151], v1, s[32:35], s67 offen offset:2176 nt
  buffer_load_dwordx4 v[152:155], v1, s[32:35], s67 offen offset:2304 nt
  buffer_load_dwordx4 v[156:159], v1, s[32:35], s67 offen offset:2432 nt
  buffer_load_dwordx4 v[160:163], v2, s[36:39], s67 offen offset:0 nt
  buffer_load_dwordx4 v[164:167], v2, s[36:39], s67 offen offset:256 nt
  buffer_load_dwordx4 v[168:171], v2, s[36:39], s67 offen offset:1024 nt
  buffer_load_dwordx4 v[172:175], v2, s[36:39], s67 offen offset:1280 nt
  buffer_load_dwordx4 v[176:179], v2, s[36:39], s67 offen offset:2048 nt
  buffer_load_dwordx4 v[180:183], v2, s[36:39], s67 offen offset:2304 nt
  buffer_load_dwordx4 v[184:187], v2, s[36:39], s67 offen offset:3072 nt
  buffer_load_dwordx4 v[188:191], v2, s[36:39], s67 offen offset:3328 nt
L_tk1:
  s_mov_b32 s75, 1
  s_atomic_add s75, s[40:41], s21 glc
L_top2:
  s_cmp_eq_u32 s45, 1
  s_cbranch_scc1 L_cv2
  s_cmp_eq_u32 s45, 2
  s_cbranch_scc1 L_cm2
  s_waitcnt vmcnt(32)
  v_mfma_f32_16x16x32_bf16 v[40:43], v[192:195], v[24:27], 0
  v_mfma_f32_16x16x32_bf16 v[44:47], v[208:211], v[24:27], 0
  v_mfma_f32_16x16x32_bf16 v[48:51], v[224:227], v[24:27], 0
  v_mfma_f32_16x16x32_bf16 v[52:55], v[240:243], v[24:27], 0
  v_mfma_f32_16x16x32_bf16 v[40:43], v[196:199], v[28:31], v[40:43]
  v_mfma_f32_16x16x32_bf16 v[44:47], v[212:215], v[28:31], v[44:47]
  v_mfma_f32_16x16x32_bf16 v[48:51], v[228:231], v[28:31], v[48:51]
  v_mfma_f32_16x16x32_bf16 v[52:55], v[244:247], v[28:31], v[52:55]
  v_mfma_f32_16x16x32_bf16 v[40:43], v[200:203], v[32:35], v[40:43]
  v_mfma_f32_16x16x32_bf16 v[44:47], v[216:219], v[32:35], v[44:47]
  v_mfma_f32_16x16x32_bf16 v[48:51], v[232:235], v[32:35], v[48:51]
  v_mfma_f32_16x16x32_bf16 v[52:55], v[248:251], v[32:35], v[52:55]
  v_mfma_f32_16x16x32_bf16 v[40:43], v[204:207], v[36:39], v[40:43]
  v_mfma_f32_16x16x32_bf16 v[44:47], v[220:223], v[36:39], v[44:47]
  v_mfma_f32_16x16x32_bf16 v[48:51], v[236:239], v[36:39], v[48:51]
  v_mfma_f32_16x16x32_bf16 v[52:55], v[252:255], v[36:39], v[52:55]
  s_nop 7
  v_cndmask_b32 v40, v40, v41, s[46:47]
  v_cndmask_b32 v42, v42, v43, s[46:47]
  v_cndmask_b32 v44, v44, v45, s[46:47]
  v_cndmask_b32 v46, v46, v47, s[46:47]
  v_cndmask_b32 v48, v48, v49, s[46:47]
  v_cndmask_b32 v50, v50, v51, s[46:47]
  v_cndmask_b32 v52, v52, v53, s[46:47]
  v_cndmask_b32 v54, v54, v55, s[46:47]
  v_add_f32_dpp v40, v40, v40 quad_perm:[1,0,3,2] row_mask:0xf bank_mask:0xf
  v_add_f32_dpp v42, v42, v42 quad_perm:[1,0,3,2] row_mask:0xf bank_mask:0xf
  v_add_f32_dpp v44, v44, v44 quad_perm:[1,0,3,2] row_mask:0xf bank_mask:0xf
  v_add_f32_dpp v46, v46, v46 quad_perm:[1,0,3,2] row_mask:0xf bank_mask:0xf
  v_add_f32_dpp v48, v48, v48 quad_perm:[1,0,3,2] row_mask:0xf bank_mask:0xf
  v_add_f32_dpp v50, v50, v50 quad_perm:[1,0,3,2] row_mask:0xf bank_mask:0xf
  v_add_f32_dpp v52, v52, v52 quad_perm:[1,0,3,2] row_mask:0xf bank_mask:0xf
  v_add_f32_dpp v54, v54, v54 quad_perm:[1,0,3,2] row_mask:0xf bank_mask:0xf
  v_max3_f32 v6, v6, v40, v42
  v_max3_f32 v6, v6, v44, v46
  v_cvt_pk_bf16_f32 v40, v40, v42
  v_cvt_pk_bf16_f32 v41, v44, v46
  v_max3_f32 v6, v6, v48, v50
  v_max3_f32 v6, v6, v52, v54
  v_cvt_pk_bf16_f32 v48, v48, v50
  v_cvt_pk_bf16_f32 v49, v52, v54
  s_mov_b64 exec, s[76:77]
  ds_write_b64 v15, v[40:41]
  ds_write_b64 v15, v[48:49] offset:64
  s_mov_b64 exec, -1
  v_add_u32 v15, 128, v15
  s_branch L_next2
L_cv2:
  ds_read_b64 v[40:41], v15
  ds_read_b64 v[42:43], v15 offset:64
  v_add_u32 v15, 128, v15
  s_cmp_lg_u32 s74, 0
  s_cbranch_scc1 L_dwv2
  s_waitcnt vmcnt(32)
L_dwbv2:
  s_waitcnt lgkmcnt(0)
  v_lshlrev_b32 v44, 16, v40
  v_and_b32 v45, 0xffff0000, v40
  v_lshlrev_b32 v46, 16, v41
  v_and_b32 v47, 0xffff0000, v41
  v_fma_f32 v48, v44, s69, -v7
  v_fma_f32 v49, v45, s69, -v7
  v_fma_f32 v50, v46, s69, -v7
  v_fma_f32 v51, v47, s69, -v7
  v_exp_f32 v48, v48
  v_exp_f32 v49, v49
  v_exp_f32 v50, v50
  v_exp_f32 v51, v51
  s_nop 0
  v_cvt_pk_bf16_f32 v52, v48, v48
  v_cvt_pk_bf16_f32 v53, v49, v49
  v_cvt_pk_bf16_f32 v54, v50, v50
  v_cvt_pk_bf16_f32 v55, v51, v51
  v_and_b32 v24, v52, v8
  v_and_b32 v25, v52, v9
  v_and_b32 v26, v52, v10
  v_and_b32 v27, v52, v11
  v_and_b32 v28, v53, v8
  v_and_b32 v29, v53, v9
  v_and_b32 v30, v53, v10
  v_and_b32 v31, v53, v11
  v_and_b32 v32, v54, v8
  v_and_b32 v33, v54, v9
  v_and_b32 v34, v54, v10
  v_and_b32 v35, v54, v11
  v_and_b32 v36, v55, v8
  v_and_b32 v37, v55, v9
  v_and_b32 v38, v55, v10
  v_and_b32 v39, v55, v11
  v_add_f32 v48, v48, v49
  v_add_f32 v50, v50, v51
  v_add_f32 v13, v13, v48
  v_add_f32 v13, v13, v50
  v_mfma_f32_16x16x32_bf16 v[16:19], v[24:27], v[192:195], v[16:19]
  v_mfma_f32_16x16x32_bf16 v[20:23], v[24:27], v[196:199], v[20:23]
  v_mfma_f32_16x16x32_bf16 v[16:19], v[28:31], v[200:203], v[16:19]
  v_mfma_f32_16x16x32_bf16 v[20:23], v[28:31], v[204:207], v[20:23]
  v_mfma_f32_16x16x32_bf16 v[16:19], v[32:35], v[208:211], v[16:19]
  v_mfma_f32_16x16x32_bf16 v[20:23], v[32:35], v[212:215], v[20:23]
  v_mfma_f32_16x16x32_bf16 v[16:19], v[36:39], v[216:219], v[16:19]
  v_mfma_f32_16x16x32_bf16 v[20:23], v[36:39], v[220:223], v[20:23]
  v_lshlrev_b32 v44, 16, v42
  v_and_b32 v45, 0xffff0000, v42
  v_lshlrev_b32 v46, 16, v43
  v_and_b32 v47, 0xffff0000, v43
  v_fma_f32 v48, v44, s69, -v7
  v_fma_f32 v49, v45, s69, -v7
  v_fma_f32 v50, v46, s69, -v7
  v_fma_f32 v51, v47, s69, -v7
  v_exp_f32 v48, v48
  v_exp_f32 v49, v49
  v_exp_f32 v50, v50
  v_exp_f32 v51, v51
  s_nop 0
  v_cvt_pk_bf16_f32 v52, v48, v48
  v_cvt_pk_bf16_f32 v53, v49, v49
  v_cvt_pk_bf16_f32 v54, v50, v50
  v_cvt_pk_bf16_f32 v55, v51, v51
  v_and_b32 v24, v52, v8
  v_and_b32 v25, v52, v9
  v_and_b32 v26, v52, v10
  v_and_b32 v27, v52, v11
  v_and_b32 v28, v53, v8
  v_and_b32 v29, v53, v9
  v_and_b32 v30, v53, v10
  v_and_b32 v31, v53, v11
  v_and_b32 v32, v54, v8
  v_and_b32 v33, v54, v9
  v_and_b32 v34, v54, v10
  v_and_b32 v35, v54, v11
  v_and_b32 v36, v55, v8
  v_and_b32 v37, v55, v9
  v_and_b32 v38, v55, v10
  v_and_b32 v39, v55, v11
  v_add_f32 v48, v48, v49
  v_add_f32 v50, v50, v51
  v_add_f32 v13, v13, v48
  v_add_f32 v13, v13, v50
  v_mfma_f32_16x16x32_bf16 v[16:19], v[24:27], v[224:227], v[16:19]
  v_mfma_f32_16x16x32_bf16 v[20:23], v[24:27], v[228:231], v[20:23]
  v_mfma_f32_16x16x32_bf16 v[16:19], v[28:31], v[232:235], v[16:19]
  v_mfma_f32_16x16x32_bf16 v[20:23], v[28:31], v[236:239], v[20:23]
  v_mfma_f32_16x16x32_bf16 v[16:19], v[32:35], v[240:243], v[16:19]
  v_mfma_f32_16x16x32_bf16 v[20:23], v[32:35], v[244:247], v[20:23]
  v_mfma_f32_16x16x32_bf16 v[16:19], v[36:39], v[248:251], v[16:19]
  v_mfma_f32_16x16x32_bf16 v[20:23], v[36:39], v[252:255], v[20:23]
  s_branch L_next2
L_cm2:
  s_waitcnt vmcnt(40)
  v_mfma_f32_16x16x32_bf16 v[40:43], v[192:195], v[24:27], 0
  v_mfma_f32_16x16x32_bf16 v[44:47], v[208:211], v[24:27], 0
  v_mfma_f32_16x16x32_bf16 v[40:43], v[196:199], v[28:31], v[40:43]
  v_mfma_f32_16x16x32_bf16 v[44:47], v[212:215], v[28:31], v[44:47]
  v_mfma_f32_16x16x32_bf16 v[40:43], v[200:203], v[32:35], v[40:43]
  v_mfma_f32_16x16x32_bf16 v[44:47], v[216:219], v[32:35], v[44:47]
  v_mfma_f32_16x16x32_bf16 v[40:43], v[204:207], v[36:39], v[40:43]
  v_mfma_f32_16x16x32_bf16 v[44:47], v[220:223], v[36:39], v[44:47]
  s_nop 7
  v_cndmask_b32 v40, v40, v41, s[46:47]
  v_cndmask_b32 v42, v42, v43, s[46:47]
  v_cndmask_b32 v44, v44, v45, s[46:47]
  v_cndmask_b32 v46, v46, v47, s[46:47]
  v_add_f32_dpp v40, v40, v40 quad_perm:[1,0,3,2] row_mask:0xf bank_mask:0xf
  v_add_f32_dpp v42, v42, v42 quad_perm:[1,0,3,2] row_mask:0xf bank_mask:0xf
  v_add_f32_dpp v44, v44, v44 quad_perm:[1,0,3,2] row_mask:0xf bank_mask:0xf
  v_add_f32_dpp v46, v46, v46 quad_perm:[1,0,3,2] row_mask:0xf bank_mask:0xf
  v_cvt_pk_bf16_f32 v56, v40, v42
  v_cvt_pk_bf16_f32 v57, v44, v46
  v_lshlrev_b32 v40, 16, v56
  v_and_b32 v42, 0xffff0000, v56
  v_lshlrev_b32 v44, 16, v57
  v_and_b32 v46, 0xffff0000, v57
  v_max3_f32 v56, v40, v42, v44
  v_max_f32 v56, v56, v46
  v_cmp_gt_f32 vcc, v56, v6
  s_cbranch_vccnz L_rare2
L_back2:
  v_fma_f32 v48, v40, s69, -v7
  v_fma_f32 v49, v42, s69, -v7
  v_fma_f32 v50, v44, s69, -v7
  v_fma_f32 v51, v46, s69, -v7
  v_exp_f32 v48, v48
  v_exp_f32 v49, v49
  v_exp_f32 v50, v50
  v_exp_f32 v51, v51
  s_nop 0
  v_cvt_pk_bf16_f32 v52, v48, v48
  v_cvt_pk_bf16_f32 v53, v49, v49
  v_cvt_pk_bf16_f32 v54, v50, v50
  v_cvt_pk_bf16_f32 v55, v51, v51
  v_and_b32 v192, v52, v8
  v_and_b32 v193, v52, v9
  v_and_b32 v194, v52, v10
  v_and_b32 v195, v52, v11
  v_and_b32 v196, v53, v8
  v_and_b32 v197, v53, v9
  v_and_b32 v198, v53, v10
  v_and_b32 v199, v53, v11
  v_and_b32 v200, v54, v8
  v_and_b32 v201, v54, v9
  v_and_b32 v202, v54, v10
  v_and_b32 v203, v54, v11
  v_and_b32 v204, v55, v8
  v_and_b32 v205, v55, v9
  v_and_b32 v206, v55, v10
  v_and_b32 v207, v55, v11
  v_add_f32 v48, v48, v49
  v_add_f32 v50, v50, v51
  v_add_f32 v13, v13, v48
  v_add_f32 v13, v13, v50
  s_cmp_lg_u32 s74, 0
  s_cbranch_scc1 L_dwm2
  s_waitcnt vmcnt(32)
L_dwbm2:
  v_mfma_f32_16x16x32_bf16 v[16:19], v[192:195], v[224:227], v[16:19]
  v_mfma_f32_16x16x32_bf16 v[20:23], v[192:195], v[228:231], v[20:23]
  v_mfma_f32_16x16x32_bf16 v[16:19], v[196:199], v[232:235], v[16:19]
  v_mfma_f32_16x16x32_bf16 v[20:23], v[196:199], v[236:239], v[20:23]
  v_mfma_f32_16x16x32_bf16 v[16:19], v[200:203], v[240:243], v[16:19]
  v_mfma_f32_16x16x32_bf16 v[20:23], v[200:203], v[244:247], v[20:23]
  v_mfma_f32_16x16x32_bf16 v[16:19], v[204:207], v[248:251], v[16:19]
  v_mfma_f32_16x16x32_bf16 v[20:23], v[204:207], v[252:255], v[20:23]
L_next2:
  s_add_u32 s42, s42, 1
  s_cmp_eq_u32 s42, s12
  s_cbranch_scc1 L_ctk2
  s_cmp_eq_u32 s42, s13
  s_cbranch_scc1 L_ctv2
L_ctb2:
  s_cmp_lg_u32 s74, 0
  s_cbranch_scc1 L_dn2
  s_cmp_eq_u32 s44, 2
  s_cbranch_scc1 L_im2
  s_cmp_eq_u32 s44, 1
  s_cbranch_scc1 L_iv2
L_ik2:
  s_cmp_ge_u32 s43, s5
  s_cbranch_scc1 L_ikt2
  s_mov_b32 s67, s31
  s_bfe_u32 s70, s43, 0x40000
  s_lshl_b32 s70, s70, 17
  s_or_b32 s67, s67, s70
  s_bfe_u32 s70, s43, 0x10004
  s_lshl_b32 s70, s70, 22
  s_or_b32 s67, s67, s70
L_ikg2:
  s_mov_b32 m0, s43
  s_add_u32 s43, s43, 1
  s_add_u32 s68, s68, 1
  v_writelane_b32 v60, s67, m0
  s_waitcnt vmcnt(12)
  buffer_load_dwordx4 v[192:195], v1, s[32:35], s67 offen offset:0 nt
  s_waitcnt vmcnt(12)
  buffer_load_dwordx4 v[196:199], v1, s[32:35], s67 offen offset:128 nt
  s_waitcnt vmcnt(12)
  buffer_load_dwordx4 v[200:203], v1, s[32:35], s67 offen offset:256 nt
  s_waitcnt vmcnt(12)
  buffer_load_dwordx4 v[204:207], v1, s[32:35], s67 offen offset:384 nt
  s_waitcnt vmcnt(12)
  buffer_load_dwordx4 v[208:211], v1, s[32:35], s67 offen offset:2048 nt
  s_waitcnt vmcnt(12)
  buffer_load_dwordx4 v[212:215], v1, s[32:35], s67 offen offset:2176 nt
  s_waitcnt vmcnt(12)
  buffer_load_dwordx4 v[216:219], v1, s[32:35], s67 offen offset:2304 nt
  s_waitcnt vmcnt(12)
  buffer_load_dwordx4 v[220:223], v1, s[32:35], s67 offen offset:2432 nt
  s_waitcnt vmcnt(12)
  buffer_load_dwordx4 v[224:227], v1, s[32:35], s67 offen offset:512 nt
  s_waitcnt vmcnt(12)
  buffer_load_dwordx4 v[228:231], v1, s[32:35], s67 offen offset:640 nt
  s_waitcnt vmcnt(12)
  buffer_load_dwordx4 v[232:235], v1, s[32:35], s67 offen offset:768 nt
  s_waitcnt vmcnt(12)
  buffer_load_dwordx4 v[236:239], v1, s[32:35], s67 offen offset:896 nt
  s_waitcnt vmcnt(12)
  buffer_load_dwordx4 v[240:243], v1, s[32:35], s67 offen offset:2560 nt
  s_waitcnt vmcnt(12)
  buffer_load_dwordx4 v[244:247], v1, s[32:35], s67 offen offset:2688 nt
  s_waitcnt vmcnt(12)
  buffer_load_dwordx4 v[248:251], v1, s[32:35], s67 offen offset:2816 nt
  s_waitcnt vmcnt(12)
  buffer_load_dwordx4 v[252:255], v1, s[32:35], s67 offen offset:2944 nt
  s_cmp_lt_u32 s43, s5
  s_cbranch_scc1 L_ikn2
  s_mov_b32 s75, -1
  s_cmp_ge_u32 s43, 48
  s_cbranch_scc1 L_ikn2
  s_cmp_eq_u32 s10, 0
  s_cbranch_scc1 L_ikn2
  s_mov_b32 s75, 1
  s_atomic_add s75, s[40:41], s21 glc
L_ikn2:
  s_cmp_eq_u32 s20, 0
  s_cbranch_scc1 L_top0
  s_mov_b32 s20, 0
  s_barrier
  s_branch L_top0
L_iv2:
  s_cmp_eq_u32 s43, s11
  s_cbranch_scc1 L_ive2
  v_readlane_b32 s67, v60, s43
  s_add_u32 s43, s43, 1
  s_add_u32 s68, s68, 1
  s_nop 3
  s_waitcnt vmcnt(12)
  buffer_load_dwordx4 v[192:195], v2, s[36:39], s67 offen offset:0 nt
  s_waitcnt vmcnt(12)
  buffer_load_dwordx4 v[196:199], v2, s[36:39], s67 offen offset:256 nt
  s_waitcnt vmcnt(12)
  buffer_load_dwordx4 v[200:203], v2, s[36:39], s67 offen offset:1024 nt
  s_waitcnt vmcnt(12)
  buffer_load_dwordx4 v[204:207], v2, s[36:39], s67 offen offset:1280 nt
  s_waitcnt vmcnt(12)
  buffer_load_dwordx4 v[208:211], v2, s[36:39], s67 offen offset:2048 nt
  s_waitcnt vmcnt(12)
  buffer_load_dwordx4 v[212:215], v2, s[36:39], s67 offen offset:2304 nt
  s_waitcnt vmcnt(12)
  buffer_load_dwordx4 v[216:219], v2, s[36:39], s67 offen offset:3072 nt
  s_waitcnt vmcnt(12)
  buffer_load_dwordx4 v[220:223], v2, s[36:39], s67 offen offset:3328 nt
  s_waitcnt vmcnt(12)
  buffer_load_dwordx4 v[224:227], v2, s[36:39], s67 offen offset:512 nt
  s_waitcnt vmcnt(12)
  buffer_load_dwordx4 v[228:231], v2, s[36:39], s67 offen offset:768 nt
  s_waitcnt vmcnt(12)
  buffer_load_dwordx4 v[232:235], v2, s[36:39], s67 offen offset:1536 nt
  s_waitcnt vmcnt(12)
  buffer_load_dwordx4 v[236:239], v2, s[36:39], s67 offen offset:1792 nt
  s_waitcnt vmcnt(12)
  buffer_load_dwordx4 v[240:243], v2, s[36:39], s67 offen offset:2560 nt
  s_waitcnt vmcnt(12)
  buffer_load_dwordx4 v[244:247], v2, s[36:39], s67 offen offset:2816 nt
  s_waitcnt vmcnt(12)
  buffer_load_dwordx4 v[248:251], v2, s[36:39], s67 offen offset:3584 nt
  s_waitcnt vmcnt(12)
  buffer_load_dwordx4 v[252:255], v2, s[36:39], s67 offen offset:3840 nt
  s_cmp_lg_u32 s43, s11
  s_cbranch_scc1 L_top0
  s_cmp_eq_u32 s4, 0
  s_cbranch_scc1 L_top0
  s_add_u32 s21, s66, 768
  s_mov_b32 s75, -1
  s_branch L_tk2
L_im2:
  s_waitcnt lgkmcnt(0)
  s_cmp_ge_u32 s75, 128
  s_cbranch_scc1 L_dn2
  s_bfe_u32 s67, s75, 0x20000
  s_lshl_b32 s67, s67, 15
  s_bfe_u32 s70, s75, 0x10002
  s_lshl_b32 s70, s70, 14
  s_or_b32 s67, s67, s70
  s_bfe_u32 s70, s75, 0x10003
  s_lshl_b32 s70, s70, 23
  s_or_b32 s67, s67, s70
  s_bfe_u32 s70, s75, 0x10004
  s_lshl_b32 s70, s70, 21
  s_or_b32 s67, s67, s70
  s_lshr_b32 s75, s75, 5
  s_and_b32 s70, s75, 1
  s_lshl_b32 s70, s70, 9
  s_or_b32 s67, s67, s70
  s_lshr_b32 s75, s75, 1
  s_add_u32 s75, s75, 30
  s_bfe_u32 s70, s75, 0x40000
  s_lshl_b32 s70, s70, 17
  s_or_b32 s67, s67, s70
  s_bfe_u32 s70, s75, 0x10004
  s_lshl_b32 s70, s70, 22
  s_or_b32 s67, s67, s70
L_imi2:
  s_waitcnt vmcnt(4)
  buffer_load_dwordx4 v[192:195], v1, s[32:35], s67 offen offset:0 nt
  buffer_load_dwordx4 v[196:199], v1, s[32:35], s67 offen offset:128 nt
  buffer_load_dwordx4 v[200:203], v1, s[32:35], s67 offen offset:256 nt
  buffer_load_dwordx4 v[204:207], v1, s[32:35], s67 offen offset:384 nt
  buffer_load_dwordx4 v[208:211], v1, s[32:35], s67 offen offset:2048 nt
  buffer_load_dwordx4 v[212:215], v1, s[32:35], s67 offen offset:2176 nt
  buffer_load_dwordx4 v[216:219], v1, s[32:35], s67 offen offset:2304 nt
  buffer_load_dwordx4 v[220:223], v1, s[32:35], s67 offen offset:2432 nt
  buffer_load_dwordx4 v[224:227], v2, s[36:39], s67 offen offset:0 nt
  buffer_load_dwordx4 v[228:231], v2, s[36:39], s67 offen offset:256 nt
  buffer_load_dwordx4 v[232:235], v2, s[36:39], s67 offen offset:1024 nt
  buffer_load_dwordx4 v[236:239], v2, s[36:39], s67 offen offset:1280 nt
  buffer_load_dwordx4 v[240:243], v2, s[36:39], s67 offen offset:2048 nt
  buffer_load_dwordx4 v[244:247], v2, s[36:39], s67 offen offset:2304 nt
  buffer_load_dwordx4 v[248:251], v2, s[36:39], s67 offen offset:3072 nt
  buffer_load_dwordx4 v[252:255], v2, s[36:39], s67 offen offset:3328 nt
L_tk2:
  s_mov_b32 s75, 1
  s_atomic_add s75, s[40:41], s21 glc
  s_branch L_top0
L_dwv0:
  s_cmp_eq_u32 s74, 1
  s_cbranch_scc0 L_dwv0z
  s_waitcnt vmcnt(16)
  s_branch L_dwbv0
L_dwv0z:
  s_waitcnt vmcnt(0)
  s_branch L_dwbv0
L_rare0:
  v_max_f32 v56, v56, v6
  v_mov_b32 v57, v56
  s_nop 1
  v_permlane16_swap_b32 v56, v57
  s_nop 0
  v_max_f32 v56, v56, v57
  v_mov_b32 v57, v56
  s_nop 1
  v_permlane32_swap_b32 v56, v57
  s_nop 0
  v_max_f32 v56, v56, v57
  v_sub_f32 v57, v6, v56
  v_mul_f32 v57, s69, v57
  v_exp_f32 v57, v57
  v_mov_b32 v6, v56
  v_mul_f32 v7, s69, v56
  v_mul_f32 v13, v13, v57
  v_mul_f32 v16, v16, v57
  v_mul_f32 v17, v17, v57
  v_mul_f32 v18, v18, v57
  v_mul_f32 v19, v19, v57
  v_mul_f32 v20, v20, v57
  v_mul_f32 v21, v21, v57
  v_mul_f32 v22, v22, v57
  v_mul_f32 v23, v23, v57
  s_branch L_back0
L_dwm0:
  s_cmp_eq_u32 s74, 1
  s_cbranch_scc0 L_dwm0z
  s_waitcnt vmcnt(16)
  s_branch L_dwbm0
L_dwm0z:
  s_waitcnt vmcnt(0)
  s_branch L_dwbm0
L_ctk0:
  v_mov_b32 v56, v6
  s_nop 1
  v_permlane16_swap_b32 v6, v56
  s_nop 0
  v_max_f32 v6, v6, v56
  v_mov_b32 v56, v6
  s_nop 1
  v_permlane32_swap_b32 v6, v56
  s_nop 0
  v_max_f32 v6, v6, v56
  v_cvt_pk_bf16_f32 v6, v6, v6
  v_and_b32 v6, 0xffff0000, v6
  v_mul_f32 v7, s69, v6
  v_mov_b32 v15, v59
  s_mov_b32 s45, 1
  s_branch L_ctb0
L_ctv0:
  s_cmp_lg_u32 s22, 0
  s_cbranch_scc1 L_ctw0
  v_mov_b32 v56, v13
  s_nop 1
  v_permlane16_swap_b32 v13, v56
  s_nop 0
  v_add_f32 v13, v13, v56
  v_mov_b32 v56, v13
  s_nop 1
  v_permlane32_swap_b32 v13, v56
  s_nop 0
  v_add_f32 v13, v13, v56
  v_add_u32 v56, s72, v14
  v_add_u32 v57, s72, v0
  v_mov_b32 v40, v7
  v_mov_b32 v41, v13
  ds_write_b128 v56, v[16:19]
  ds_write_b128 v56, v[20:23] offset:512
  s_mov_b64 exec, 0x101
  ds_write_b64 v57, v[40:41] offset:2048
  s_mov_b64 exec, -1
  ds_read_b128 v[24:27], v58 offset:0
  ds_read_b128 v[28:31], v58 offset:128
  ds_read_b128 v[32:35], v58 offset:256
  ds_read_b128 v[36:39], v58 offset:384
  s_waitcnt lgkmcnt(0)
  v_mov_b32 v6, 0xff7fffff
  v_mov_b32 v13, 0
  v_mov_b32 v15, v59
  s_mov_b32 s45, 0
  s_mov_b32 s22, 1
  s_mov_b32 s20, 1
  v_mov_b32 v16, 0
  v_mov_b32 v17, 0
  v_mov_b32 v18, 0
  v_mov_b32 v19, 0
  v_mov_b32 v20, 0
  v_mov_b32 v21, 0
  v_mov_b32 v22, 0
  v_mov_b32 v23, 0
  s_branch L_ctb0
L_ctw0:
  ds_read_b128 v[24:27], v58 offset:0
  ds_read_b128 v[28:31], v58 offset:128
  ds_read_b128 v[32:35], v58 offset:256
  ds_read_b128 v[36:39], v58 offset:384
  s_waitcnt lgkmcnt(0)
  s_mov_b32 s45, 2
  s_branch L_ctb0
L_ikt0:
  s_waitcnt lgkmcnt(0)
  s_cmp_ge_u32 s75, s10
  s_cbranch_scc1 L_ike0
  s_cmp_lg_u32 s4, 0
  s_cbranch_scc1 L_iktb0
  s_bfe_u32 s67, s75, 0x20000
  s_lshl_b32 s67, s67, 15
  s_bfe_u32 s70, s75, 0x10002
  s_lshl_b32 s70, s70, 14
  s_or_b32 s67, s67, s70
  s_bfe_u32 s70, s75, 0x20003
  s_lshl_b32 s70, s70, 22
  s_or_b32 s67, s67, s70
  s_lshr_b32 s75, s75, 5
  s_branch L_iktc0
L_iktb0:
  s_bfe_u32 s67, s75, 0x20000
  s_lshl_b32 s67, s67, 15
  s_bfe_u32 s70, s75, 0x10002
  s_lshl_b32 s70, s70, 14
  s_or_b32 s67, s67, s70
  s_bfe_u32 s70, s75, 0x10003
  s_lshl_b32 s70, s70, 23
  s_or_b32 s67, s67, s70
  s_lshr_b32 s75, s75, 4
L_iktc0:
  s_and_b32 s70, s75, 1
  s_lshl_b32 s70, s70, 21
  s_or_b32 s67, s67, s70
  s_lshr_b32 s75, s75, 1
  s_add_u32 s75, s75, s5
  s_bfe_u32 s70, s75, 0x40000
  s_lshl_b32 s70, s70, 17
  s_or_b32 s67, s67, s70
  s_bfe_u32 s70, s75, 0x10004
  s_lshl_b32 s70, s70, 22
  s_or_b32 s67, s67, s70
  s_branch L_ikg0
L_ike0:
  s_mov_b32 s11, s43
  s_mov_b32 s12, s68
  s_add_u32 s13, s68, s43
  s_mov_b32 s43, 0
  s_mov_b32 s44, 1
  s_branch L_iv0
L_ive0:
  s_cmp_lg_u32 s4, 0
  s_cbranch_scc1 L_ivm0
  s_mov_b32 s4, 1
  s_mov_b32 s43, 0
  s_mov_b32 s44, 0
  s_mov_b32 s31, s30
  s_mov_b32 s5, 28
  s_mov_b32 s10, 64
  s_add_u32 s21, s66, 256
  s_add_u32 s32, s16, s64
  s_addc_u32 s33, s17, 0
  s_add_u32 s36, s18, s64
  s_addc_u32 s37, s19, 0
  s_branch L_ik0
L_ivm0:
  s_mov_b32 s44, 2
  s_branch L_im0
L_dn0:
  s_add_u32 s74, s74, 1
  s_cmp_eq_u32 s74, 3
  s_cbranch_scc1 L_done
  s_cmp_eq_u32 s74, 1
  s_cbranch_scc0 L_dn0b
  s_barrier
  s_waitcnt vmcnt(24)
  s_branch L_top1
L_dn0b:
  s_waitcnt vmcnt(8)
  s_branch L_top1
L_dwv1:
  s_cmp_eq_u32 s74, 1
  s_cbranch_scc0 L_dwv1z
  s_waitcnt vmcnt(16)
  s_branch L_dwbv1
L_dwv1z:
  s_waitcnt vmcnt(0)
  s_branch L_dwbv1
L_rare1:
  v_max_f32 v56, v56, v6
  v_mov_b32 v57, v56
  s_nop 1
  v_permlane16_swap_b32 v56, v57
  s_nop 0
  v_max_f32 v56, v56, v57
  v_mov_b32 v57, v56
  s_nop 1
  v_permlane32_swap_b32 v56, v57
  s_nop 0
  v_max_f32 v56, v56, v57
  v_sub_f32 v57, v6, v56
  v_mul_f32 v57, s69, v57
  v_exp_f32 v57, v57
  v_mov_b32 v6, v56
  v_mul_f32 v7, s69, v56
  v_mul_f32 v13, v13, v57
  v_mul_f32 v16, v16, v57
  v_mul_f32 v17, v17, v57
  v_mul_f32 v18, v18, v57
  v_mul_f32 v19, v19, v57
  v_mul_f32 v20, v20, v57
  v_mul_f32 v21, v21, v57
  v_mul_f32 v22, v22, v57
  v_mul_f32 v23, v23, v57
  s_branch L_back1
L_dwm1:
  s_cmp_eq_u32 s74, 1
  s_cbranch_scc0 L_dwm1z
  s_waitcnt vmcnt(16)
  s_branch L_dwbm1
L_dwm1z:
  s_waitcnt vmcnt(0)
  s_branch L_dwbm1
L_ctk1:
  v_mov_b32 v56, v6
  s_nop 1
  v_permlane16_swap_b32 v6, v56
  s_nop 0
  v_max_f32 v6, v6, v56
  v_mov_b32 v56, v6
  s_nop 1
  v_permlane32_swap_b32 v6, v56
  s_nop 0
  v_max_f32 v6, v6, v56
  v_cvt_pk_bf16_f32 v6, v6, v6
  v_and_b32 v6, 0xffff0000, v6
  v_mul_f32 v7, s69, v6
  v_mov_b32 v15, v59
  s_mov_b32 s45, 1
  s_branch L_ctb1
L_ctv1:
  s_cmp_lg_u32 s22, 0
  s_cbranch_scc1 L_ctw1
  v_mov_b32 v56, v13
  s_nop 1
  v_permlane16_swap_b32 v13, v56
  s_nop 0
  v_add_f32 v13, v13, v56
  v_mov_b32 v56, v13
  s_nop 1
  v_permlane32_swap_b32 v13, v56
  s_nop 0
  v_add_f32 v13, v13, v56
  v_add_u32 v56, s72, v14
  v_add_u32 v57, s72, v0
  v_mov_b32 v40, v7
  v_mov_b32 v41, v13
  ds_write_b128 v56, v[16:19]
  ds_write_b128 v56, v[20:23] offset:512
  s_mov_b64 exec, 0x101
  ds_write_b64 v57, v[40:41] offset:2048
  s_mov_b64 exec, -1
  ds_read_b128 v[24:27], v58 offset:0
  ds_read_b128 v[28:31], v58 offset:128
  ds_read_b128 v[32:35], v58 offset:256
  ds_read_b128 v[36:39], v58 offset:384
  s_waitcnt lgkmcnt(0)
  v_mov_b32 v6, 0xff7fffff
  v_mov_b32 v13, 0
  v_mov_b32 v15, v59
  s_mov_b32 s45, 0
  s_mov_b32 s22, 1
  s_mov_b32 s20, 1
  v_mov_b32 v16, 0
  v_mov_b32 v17, 0
  v_mov_b32 v18, 0
  v_mov_b32 v19, 0
  v_mov_b32 v20, 0
  v_mov_b32 v21, 0
  v_mov_b32 v22, 0
  v_mov_b32 v23, 0
  s_branch L_ctb1
L_ctw1:
  ds_read_b128 v[24:27], v58 offset:0
  ds_read_b128 v[28:31], v58 offset:128
  ds_read_b128 v[32:35], v58 offset:256
  ds_read_b128 v[36:39], v58 offset:384
  s_waitcnt lgkmcnt(0)
  s_mov_b32 s45, 2
  s_branch L_ctb1
L_ikt1:
  s_waitcnt lgkmcnt(0)
  s_cmp_ge_u32 s75, s10
  s_cbranch_scc1 L_ike1
  s_cmp_lg_u32 s4, 0
  s_cbranch_scc1 L_iktb1
  s_bfe_u32 s67, s75, 0x20000
  s_lshl_b32 s67, s67, 15
  s_bfe_u32 s70, s75, 0x10002
  s_lshl_b32 s70, s70, 14
  s_or_b32 s67, s67, s70
  s_bfe_u32 s70, s75, 0x20003
  s_lshl_b32 s70, s70, 22
  s_or_b32 s67, s67, s70
  s_lshr_b32 s75, s75, 5
  s_branch L_iktc1
L_iktb1:
  s_bfe_u32 s67, s75, 0x20000
  s_lshl_b32 s67, s67, 15
  s_bfe_u32 s70, s75, 0x10002
  s_lshl_b32 s70, s70, 14
  s_or_b32 s67, s67, s70
  s_bfe_u32 s70, s75, 0x10003
  s_lshl_b32 s70, s70, 23
  s_or_b32 s67, s67, s70
  s_lshr_b32 s75, s75, 4
L_iktc1:
  s_and_b32 s70, s75, 1
  s_lshl_b32 s70, s70, 21
  s_or_b32 s67, s67, s70
  s_lshr_b32 s75, s75, 1
  s_add_u32 s75, s75, s5
  s_bfe_u32 s70, s75, 0x40000
  s_lshl_b32 s70, s70, 17
  s_or_b32 s67, s67, s70
  s_bfe_u32 s70, s75, 0x10004
  s_lshl_b32 s70, s70, 22
  s_or_b32 s67, s67, s70
  s_branch L_ikg1
L_ike1:
  s_mov_b32 s11, s43
  s_mov_b32 s12, s68
  s_add_u32 s13, s68, s43
  s_mov_b32 s43, 0
  s_mov_b32 s44, 1
  s_branch L_iv1
L_ive1:
  s_cmp_lg_u32 s4, 0
  s_cbranch_scc1 L_ivm1
  s_mov_b32 s4, 1
  s_mov_b32 s43, 0
  s_mov_b32 s44, 0
  s_mov_b32 s31, s30
  s_mov_b32 s5, 28
  s_mov_b32 s10, 64
  s_add_u32 s21, s66, 256
  s_add_u32 s32, s16, s64
  s_addc_u32 s33, s17, 0
  s_add_u32 s36, s18, s64
  s_addc_u32 s37, s19, 0
  s_branch L_ik1
L_ivm1:
  s_mov_b32 s44, 2
  s_branch L_im1
L_dn1:
  s_add_u32 s74, s74, 1
  s_cmp_eq_u32 s74, 3
  s_cbranch_scc1 L_done
  s_cmp_eq_u32 s74, 1
  s_cbranch_scc0 L_dn1b
  s_barrier
  s_waitcnt vmcnt(24)
  s_branch L_top2
L_dn1b:
  s_waitcnt vmcnt(8)
  s_branch L_top2
L_dwv2:
  s_cmp_eq_u32 s74, 1
  s_cbranch_scc0 L_dwv2z
  s_waitcnt vmcnt(16)
  s_branch L_dwbv2
L_dwv2z:
  s_waitcnt vmcnt(0)
  s_branch L_dwbv2
L_rare2:
  v_max_f32 v56, v56, v6
  v_mov_b32 v57, v56
  s_nop 1
  v_permlane16_swap_b32 v56, v57
  s_nop 0
  v_max_f32 v56, v56, v57
  v_mov_b32 v57, v56
  s_nop 1
  v_permlane32_swap_b32 v56, v57
  s_nop 0
  v_max_f32 v56, v56, v57
  v_sub_f32 v57, v6, v56
  v_mul_f32 v57, s69, v57
  v_exp_f32 v57, v57
  v_mov_b32 v6, v56
  v_mul_f32 v7, s69, v56
  v_mul_f32 v13, v13, v57
  v_mul_f32 v16, v16, v57
  v_mul_f32 v17, v17, v57
  v_mul_f32 v18, v18, v57
  v_mul_f32 v19, v19, v57
  v_mul_f32 v20, v20, v57
  v_mul_f32 v21, v21, v57
  v_mul_f32 v22, v22, v57
  v_mul_f32 v23, v23, v57
  s_branch L_back2
L_dwm2:
  s_cmp_eq_u32 s74, 1
  s_cbranch_scc0 L_dwm2z
  s_waitcnt vmcnt(16)
  s_branch L_dwbm2
L_dwm2z:
  s_waitcnt vmcnt(0)
  s_branch L_dwbm2
L_ctk2:
  v_mov_b32 v56, v6
  s_nop 1
  v_permlane16_swap_b32 v6, v56
  s_nop 0
  v_max_f32 v6, v6, v56
  v_mov_b32 v56, v6
  s_nop 1
  v_permlane32_swap_b32 v6, v56
  s_nop 0
  v_max_f32 v6, v6, v56
  v_cvt_pk_bf16_f32 v6, v6, v6
  v_and_b32 v6, 0xffff0000, v6
  v_mul_f32 v7, s69, v6
  v_mov_b32 v15, v59
  s_mov_b32 s45, 1
  s_branch L_ctb2
L_ctv2:
  s_cmp_lg_u32 s22, 0
  s_cbranch_scc1 L_ctw2
  v_mov_b32 v56, v13
  s_nop 1
  v_permlane16_swap_b32 v13, v56
  s_nop 0
  v_add_f32 v13, v13, v56
  v_mov_b32 v56, v13
  s_nop 1
  v_permlane32_swap_b32 v13, v56
  s_nop 0
  v_add_f32 v13, v13, v56
  v_add_u32 v56, s72, v14
  v_add_u32 v57, s72, v0
  v_mov_b32 v40, v7
  v_mov_b32 v41, v13
  ds_write_b128 v56, v[16:19]
  ds_write_b128 v56, v[20:23] offset:512
  s_mov_b64 exec, 0x101
  ds_write_b64 v57, v[40:41] offset:2048
  s_mov_b64 exec, -1
  ds_read_b128 v[24:27], v58 offset:0
  ds_read_b128 v[28:31], v58 offset:128
  ds_read_b128 v[32:35], v58 offset:256
  ds_read_b128 v[36:39], v58 offset:384
  s_waitcnt lgkmcnt(0)
  v_mov_b32 v6, 0xff7fffff
  v_mov_b32 v13, 0
  v_mov_b32 v15, v59
  s_mov_b32 s45, 0
  s_mov_b32 s22, 1
  s_mov_b32 s20, 1
  v_mov_b32 v16, 0
  v_mov_b32 v17, 0
  v_mov_b32 v18, 0
  v_mov_b32 v19, 0
  v_mov_b32 v20, 0
  v_mov_b32 v21, 0
  v_mov_b32 v22, 0
  v_mov_b32 v23, 0
  s_branch L_ctb2
L_ctw2:
  ds_read_b128 v[24:27], v58 offset:0
  ds_read_b128 v[28:31], v58 offset:128
  ds_read_b128 v[32:35], v58 offset:256
  ds_read_b128 v[36:39], v58 offset:384
  s_waitcnt lgkmcnt(0)
  s_mov_b32 s45, 2
  s_branch L_ctb2
L_ikt2:
  s_waitcnt lgkmcnt(0)
  s_cmp_ge_u32 s75, s10
  s_cbranch_scc1 L_ike2
  s_cmp_lg_u32 s4, 0
  s_cbranch_scc1 L_iktb2
  s_bfe_u32 s67, s75, 0x20000
  s_lshl_b32 s67, s67, 15
  s_bfe_u32 s70, s75, 0x10002
  s_lshl_b32 s70, s70, 14
  s_or_b32 s67, s67, s70
  s_bfe_u32 s70, s75, 0x20003
  s_lshl_b32 s70, s70, 22
  s_or_b32 s67, s67, s70
  s_lshr_b32 s75, s75, 5
  s_branch L_iktc2
L_iktb2:
  s_bfe_u32 s67, s75, 0x20000
  s_lshl_b32 s67, s67, 15
  s_bfe_u32 s70, s75, 0x10002
  s_lshl_b32 s70, s70, 14
  s_or_b32 s67, s67, s70
  s_bfe_u32 s70, s75, 0x10003
  s_lshl_b32 s70, s70, 23
  s_or_b32 s67, s67, s70
  s_lshr_b32 s75, s75, 4
L_iktc2:
  s_and_b32 s70, s75, 1
  s_lshl_b32 s70, s70, 21
  s_or_b32 s67, s67, s70
  s_lshr_b32 s75, s75, 1
  s_add_u32 s75, s75, s5
  s_bfe_u32 s70, s75, 0x40000
  s_lshl_b32 s70, s70, 17
  s_or_b32 s67, s67, s70
  s_bfe_u32 s70, s75, 0x10004
  s_lshl_b32 s70, s70, 22
  s_or_b32 s67, s67, s70
  s_branch L_ikg2
L_ike2:
  s_mov_b32 s11, s43
  s_mov_b32 s12, s68
  s_add_u32 s13, s68, s43
  s_mov_b32 s43, 0
  s_mov_b32 s44, 1
  s_branch L_iv2
L_ive2:
  s_cmp_lg_u32 s4, 0
  s_cbranch_scc1 L_ivm2
  s_mov_b32 s4, 1
  s_mov_b32 s43, 0
  s_mov_b32 s44, 0
  s_mov_b32 s31, s30
  s_mov_b32 s5, 28
  s_mov_b32 s10, 64
  s_add_u32 s21, s66, 256
  s_add_u32 s32, s16, s64
  s_addc_u32 s33, s17, 0
  s_add_u32 s36, s18, s64
  s_addc_u32 s37, s19, 0
  s_branch L_ik2
L_ivm2:
  s_mov_b32 s44, 2
  s_branch L_im2
L_dn2:
  s_add_u32 s74, s74, 1
  s_cmp_eq_u32 s74, 3
  s_cbranch_scc1 L_done
  s_cmp_eq_u32 s74, 1
  s_cbranch_scc0 L_dn2b
  s_barrier
  s_waitcnt vmcnt(24)
  s_branch L_top0
L_dn2b:
  s_waitcnt vmcnt(8)
  s_branch L_top0
L_done:
  v_mov_b32 v56, v13
  s_nop 1
  v_permlane16_swap_b32 v13, v56
  s_nop 0
  v_add_f32 v13, v13, v56
  v_mov_b32 v56, v13
  s_nop 1
  v_permlane32_swap_b32 v13, v56
  s_nop 0
  v_add_f32 v13, v13, v56
  v_min_u32 v16, v16, v12
  v_min_u32 v17, v17, v12
  v_min_u32 v18, v18, v12
  v_min_u32 v19, v19, v12
  v_min_u32 v20, v20, v12
  v_min_u32 v21, v21, v12
  v_min_u32 v22, v22, v12
  v_min_u32 v23, v23, v12
  v_min_u32 v40, v7, v12
  v_min_u32 v41, v13, v12
  s_mov_b32 exec_hi, 0
  buffer_store_dwordx4 v[16:19], v14, s[52:55], s71 offen sc1
  buffer_store_dwordx4 v[20:23], v14, s[52:55], s71 offen offset:512 sc1
  s_mov_b32 exec_lo, 1
  buffer_store_dwordx2 v[40:41], v0, s[52:55], s73 offen sc1
  s_mov_b64 exec, -1
  s_barrier
  s_endpgm
L_helper2:
  s_add_u32 s66, s66, 1640531527
  s_mov_b32 s62, 0
  s_barrier
  s_movk_i32 s64, 7168
  v_mul_lo_u32 v6, v4, s64
  v_lshl_add_u32 v6, v3, 4, v6
  v_add_u32 v7, 3584, v6
  s_mul_i32 s64, s65, 896
  buffer_load_dwordx4 v[128:131], v6, s[48:51], s64 offen offset:0 nt
  buffer_load_dwordx4 v[132:135], v6, s[48:51], s64 offen offset:256 nt
  buffer_load_dwordx4 v[136:139], v6, s[48:51], s64 offen offset:512 nt
  buffer_load_dwordx4 v[140:143], v6, s[48:51], s64 offen offset:768 nt
  buffer_load_dwordx4 v[144:147], v6, s[48:51], s64 offen offset:896 nt
  buffer_load_dwordx4 v[148:151], v6, s[48:51], s64 offen offset:1152 nt
  buffer_load_dwordx4 v[152:155], v6, s[48:51], s64 offen offset:1408 nt
  buffer_load_dwordx4 v[156:159], v6, s[48:51], s64 offen offset:1664 nt
  buffer_load_dwordx4 v[160:163], v6, s[48:51], s64 offen offset:1792 nt
  buffer_load_dwordx4 v[164:167], v6, s[48:51], s64 offen offset:2048 nt
  buffer_load_dwordx4 v[168:171], v6, s[48:51], s64 offen offset:2304 nt
  buffer_load_dwordx4 v[172:175], v6, s[48:51], s64 offen offset:2560 nt
  buffer_load_dwordx4 v[176:179], v6, s[48:51], s64 offen offset:2688 nt
  buffer_load_dwordx4 v[180:183], v6, s[48:51], s64 offen offset:2944 nt
  buffer_load_dwordx4 v[184:187], v6, s[48:51], s64 offen offset:3200 nt
  buffer_load_dwordx4 v[188:191], v6, s[48:51], s64 offen offset:3456 nt
  buffer_load_dwordx4 v[192:195], v7, s[48:51], s64 offen offset:0 nt
  buffer_load_dwordx4 v[196:199], v7, s[48:51], s64 offen offset:256 nt
  buffer_load_dwordx4 v[200:203], v7, s[48:51], s64 offen offset:512 nt
  buffer_load_dwordx4 v[204:207], v7, s[48:51], s64 offen offset:768 nt
  buffer_load_dwordx4 v[208:211], v7, s[48:51], s64 offen offset:896 nt
  buffer_load_dwordx4 v[212:215], v7, s[48:51], s64 offen offset:1152 nt
  buffer_load_dwordx4 v[216:219], v7, s[48:51], s64 offen offset:1408 nt
  buffer_load_dwordx4 v[220:223], v7, s[48:51], s64 offen offset:1664 nt
  buffer_load_dwordx4 v[224:227], v7, s[48:51], s64 offen offset:1792 nt
  buffer_load_dwordx4 v[228:231], v7, s[48:51], s64 offen offset:2048 nt
  buffer_load_dwordx4 v[232:235], v7, s[48:51], s64 offen offset:2304 nt
  buffer_load_dwordx4 v[236:239], v7, s[48:51], s64 offen offset:2560 nt
  buffer_load_dwordx4 v[240:243], v7, s[48:51], s64 offen offset:2688 nt
  buffer_load_dwordx4 v[244:247], v7, s[48:51], s64 offen offset:2944 nt
  buffer_load_dwordx4 v[248:251], v7, s[48:51], s64 offen offset:3200 nt
  buffer_load_dwordx4 v[252:255], v7, s[48:51], s64 offen offset:3456 nt
  s_barrier
  v_and_b32 v60, 1, v0
  v_cmp_eq_u32 vcc, 1, v60
  v_mov_b32 v61, 0xffff
  v_mov_b32 v62, 0xffff0000
  v_bfe_u32 v60, v0, 1, 2
  v_cndmask_b32 v61, v61, v62, vcc
  v_cmp_eq_u32 vcc, 0, v60
  s_nop 1
  v_cndmask_b32 v8, 0, v61, vcc
  v_cmp_eq_u32 vcc, 1, v60
  s_nop 1
  v_cndmask_b32 v9, 0, v61, vcc
  v_cmp_eq_u32 vcc, 2, v60
  s_nop 1
  v_cndmask_b32 v10, 0, v61, vcc
  v_cmp_eq_u32 vcc, 3, v60
  s_nop 1
  v_cndmask_b32 v11, 0, v61, vcc
  v_mov_b32 v12, 0xfffffffe
  s_and_b32 s3, s2, 3
  s_lshr_b32 s70, s2, 3
  s_lshl_b32 s70, s70, 2
  s_or_b32 s3, s3, s70
  s_bitcmp1_b32 s2, 2
  s_cselect_b32 s3, 255, s3
  s_cmp_ge_u32 s3, 56
  s_cbranch_scc1 L_rgot
  v_lshlrev_b32 v60, 7, v0
  s_mov_b32 s4, 4096
  s_mov_b32 s5, 12288
  s_mov_b32 s6, 20480
  s_mov_b32 s7, 28672
  s_mov_b32 s74, 200000
L_rpoll:
  buffer_load_dword v16, v60, s[52:55], s4 offen offset:4 sc1
  buffer_load_dword v17, v60, s[52:55], s5 offen offset:4 sc1
  buffer_load_dword v18, v60, s[52:55], s6 offen offset:4 sc1
  buffer_load_dword v19, v60, s[52:55], s7 offen offset:4 sc1
  s_sub_u32 s74, s74, 1
  s_cbranch_scc1 L_rgot
  s_waitcnt vmcnt(0)
  v_xor_b32 v16, s66, v16
  v_xor_b32 v17, s66, v17
  v_xor_b32 v18, s66, v18
  v_xor_b32 v19, s66, v19
  v_or3_b32 v16, v16, v17, v18
  v_or_b32 v16, v16, v19
  v_cmp_ne_u32 vcc, 0, v16
  s_cbranch_vccnz L_rpoll
L_rgot:
  v_lshrrev_b32 v60, 1, v3
  v_lshlrev_b32 v60, 2, v60
  v_and_b32 v61, 1, v0
  v_add_u32 v60, v60, v61
  s_cmp_lt_u32 s63, 2
  s_cselect_b64 vcc, -1, 0
  s_movk_i32 s72, 1024
  s_cselect_b32 s72, 98304, s72
  s_cselect_b32 s73, 98304, 8
  v_cndmask_b32 v60, v60, v3, vcc
  v_mul_u32_u24 v61, 6144, v60
  v_lshl_add_u32 v60, v4, 5, v61
  s_and_b32 s71, s63, 1
  s_mul_i32 s4, s71, 12288
  s_add_u32 s6, s4, 16
  s_add_u32 s4, s4, 2048
  s_lshl_b32 s5, s71, 10
  s_lshl_b32 s7, s71, 3
  s_cmp_lt_u32 s63, 2
  s_cselect_b32 s4, s5, s4
  s_cselect_b32 s6, s7, s6
  s_mul_i32 s70, s60, 196608
  s_add_u32 s70, s70, 65536
  s_and_b32 s71, s61, 7
  s_lshl_b32 s71, s71, 7
  s_add_u32 s4, s4, s71
  s_add_u32 s4, s4, s70
  s_add_u32 s5, s4, s72
  s_add_u32 s6, s6, s70
  s_add_u32 s6, s6, 4096
  s_add_u32 s7, s6, s73
  v_lshlrev_b32 v62, 5, v3
  v_lshl_add_u32 v62, v4, 4, v62
  v_lshrrev_b32 v58, 2, v0
  v_and_b32 v59, 15, v58
  v_lshrrev_b32 v58, 4, v58
  v_lshl_add_u32 v58, v58, 5, v59
  v_mul_u32_u24 v58, 6144, v58
  v_and_b32 v59, 3, v0
  v_lshl_add_u32 v13, v59, 4, v58
  s_cmp_ge_u32 s3, 28
  s_cselect_b32 s70, 96512, 0
  s_mul_i32 s71, s3, 64
  s_add_u32 s8, s70, s71
  s_add_u32 s8, s8, 69888
  v_lshlrev_b32 v63, 3, v0
  s_mul_i32 s12, s3, 32
  s_barrier
  v_mov_b32 v15, 0
  ds_read_b128 v[16:19], v15 offset:18432
  ds_read_b128 v[28:31], v15 offset:20736
  ds_read_b128 v[112:115], v5 offset:16384
  ds_read_b128 v[116:119], v5 offset:17408
  ds_read_b128 v[20:23], v5 offset:18688
  ds_read_b128 v[24:27], v5 offset:19712
  s_waitcnt lgkmcnt(0)
  v_max_f32 v120, v16, v28
  v_sub_f32 v16, v16, v120
  v_sub_f32 v28, v28, v120
  v_exp_f32 v16, v16
  v_exp_f32 v28, v28
  s_nop 0
  v_mul_f32 v121, v16, v17
  v_fmac_f32 v121, v28, v29
  v_mul_f32 v112, v112, v16
  v_mul_f32 v113, v113, v16
  v_mul_f32 v114, v114, v16
  v_mul_f32 v115, v115, v16
  v_fmac_f32 v112, v20, v28
  v_fmac_f32 v113, v21, v28
  v_fmac_f32 v114, v22, v28
  v_fmac_f32 v115, v23, v28
  v_max_f32 v122, v18, v30
  v_sub_f32 v18, v18, v122
  v_sub_f32 v30, v30, v122
  v_exp_f32 v18, v18
  v_exp_f32 v30, v30
  s_nop 0
  v_mul_f32 v123, v18, v19
  v_fmac_f32 v123, v30, v31
  v_mul_f32 v116, v116, v18
  v_mul_f32 v117, v117, v18
  v_mul_f32 v118, v118, v18
  v_mul_f32 v119, v119, v18
  v_fmac_f32 v116, v24, v30
  v_fmac_f32 v117, v25, v30
  v_fmac_f32 v118, v26, v30
  v_fmac_f32 v119, v27, v30
  v_min_u32 v112, v112, v12
  v_min_u32 v113, v113, v12
  v_min_u32 v114, v114, v12
  v_min_u32 v115, v115, v12
  v_min_u32 v116, v116, v12
  v_min_u32 v117, v117, v12
  v_min_u32 v118, v118, v12
  v_min_u32 v119, v119, v12
  v_min_u32 v120, v120, v12
  v_min_u32 v121, v121, v12
  v_min_u32 v122, v122, v12
  v_min_u32 v123, v123, v12
  s_add_u32 s70, s69, 4096
  s_mov_b32 s74, 200000
  s_barrier
  buffer_store_dwordx4 v[112:115], v5, s[52:55], s69 offen sc1
  buffer_store_dwordx4 v[116:119], v5, s[52:55], s69 offen offset:1024 sc1
  s_mov_b64 exec, 1
  buffer_store_dwordx4 v[120:123], v15, s[52:55], s70 offen sc1
  s_mov_b64 exec, -1
  s_barrier
L_nb3:
  s_add_u32 s69, s69, 4352
L_p1:
  buffer_load_dwordx2 v[16:17], v61, s[52:55], s6 offen sc1
  buffer_load_dwordx2 v[18:19], v61, s[52:55], s7 offen sc1
  buffer_load_dwordx4 v[20:23], v60, s[52:55], s4 offen offset:0 sc1
  buffer_load_dwordx4 v[24:27], v60, s[52:55], s4 offen offset:16 sc1
  buffer_load_dwordx4 v[28:31], v60, s[52:55], s5 offen offset:0 sc1
  buffer_load_dwordx4 v[32:35], v60, s[52:55], s5 offen offset:16 sc1
  s_waitcnt vmcnt(0)
  v_max3_u32 v56, v16, v17, v18
  v_max3_u32 v57, v19, v20, v21
  v_max3_u32 v58, v22, v23, v24
  v_max3_u32 v59, v25, v26, v27
  v_max3_u32 v56, v56, v28, v29
  v_max3_u32 v57, v57, v30, v31
  v_max3_u32 v58, v58, v32, v33
  v_max3_u32 v59, v59, v34, v35
  v_max3_u32 v56, v56, v57, v58
  v_max_u32 v56, v56, v59
  v_cmp_eq_u32 vcc, -1, v56
  s_sub_u32 s74, s74, 1
  s_cbranch_scc1 L_p1got
  s_and_b64 exec, exec, vcc
  s_cbranch_scc1 L_p1
L_p1got:
  s_mov_b64 exec, -1
  v_max_f32 v56, v16, v18
  s_nop 1
  v_max_f32_dpp v56, v56, v56 row_ror:8 row_mask:0xf bank_mask:0xf
  s_nop 1
  v_max_f32_dpp v56, v56, v56 row_ror:4 row_mask:0xf bank_mask:0xf
  s_nop 1
  v_max_f32_dpp v56, v56, v56 row_ror:2 row_mask:0xf bank_mask:0xf
  s_nop 1
  v_max_f32_dpp v56, v56, v56 row_ror:1 row_mask:0xf bank_mask:0xf
  v_sub_f32 v16, v16, v56
  v_sub_f32 v18, v18, v56
  v_exp_f32 v16, v16
  v_exp_f32 v18, v18
  s_nop 0
  v_mul_f32 v56, v16, v17
  v_fmac_f32 v56, v18, v19
  v_mul_f32 v20, v20, v16
  v_mul_f32 v21, v21, v16
  v_mul_f32 v22, v22, v16
  v_mul_f32 v23, v23, v16
  v_mul_f32 v24, v24, v16
  v_mul_f32 v25, v25, v16
  v_mul_f32 v26, v26, v16
  v_mul_f32 v27, v27, v16
  v_fmac_f32 v20, v28, v18
  v_fmac_f32 v21, v29, v18
  v_fmac_f32 v22, v30, v18
  v_fmac_f32 v23, v31, v18
  v_fmac_f32 v24, v32, v18
  v_fmac_f32 v25, v33, v18
  v_fmac_f32 v26, v34, v18
  v_fmac_f32 v27, v35, v18
  v_add_f32_dpp v56, v56, v56 row_ror:8 row_mask:0xf bank_mask:0xf
  v_add_f32_dpp v20, v20, v20 row_ror:8 row_mask:0xf bank_mask:0xf
  v_add_f32_dpp v21, v21, v21 row_ror:8 row_mask:0xf bank_mask:0xf
  v_add_f32_dpp v22, v22, v22 row_ror:8 row_mask:0xf bank_mask:0xf
  v_add_f32_dpp v23, v23, v23 row_ror:8 row_mask:0xf bank_mask:0xf
  v_add_f32_dpp v24, v24, v24 row_ror:8 row_mask:0xf bank_mask:0xf
  v_add_f32_dpp v25, v25, v25 row_ror:8 row_mask:0xf bank_mask:0xf
  v_add_f32_dpp v26, v26, v26 row_ror:8 row_mask:0xf bank_mask:0xf
  v_add_f32_dpp v27, v27, v27 row_ror:8 row_mask:0xf bank_mask:0xf
  v_add_f32_dpp v56, v56, v56 row_ror:4 row_mask:0xf bank_mask:0xf
  v_add_f32_dpp v20, v20, v20 row_ror:4 row_mask:0xf bank_mask:0xf
  v_add_f32_dpp v21, v21, v21 row_ror:4 row_mask:0xf bank_mask:0xf
  v_add_f32_dpp v22, v22, v22 row_ror:4 row_mask:0xf bank_mask:0xf
  v_add_f32_dpp v23, v23, v23 row_ror:4 row_mask:0xf bank_mask:0xf
  v_add_f32_dpp v24, v24, v24 row_ror:4 row_mask:0xf bank_mask:0xf
  v_add_f32_dpp v25, v25, v25 row_ror:4 row_mask:0xf bank_mask:0xf
  v_add_f32_dpp v26, v26, v26 row_ror:4 row_mask:0xf bank_mask:0xf
  v_add_f32_dpp v27, v27, v27 row_ror:4 row_mask:0xf bank_mask:0xf
  v_add_f32_dpp v56, v56, v56 row_ror:2 row_mask:0xf bank_mask:0xf
  v_add_f32_dpp v20, v20, v20 row_ror:2 row_mask:0xf bank_mask:0xf
  v_add_f32_dpp v21, v21, v21 row_ror:2 row_mask:0xf bank_mask:0xf
  v_add_f32_dpp v22, v22, v22 row_ror:2 row_mask:0xf bank_mask:0xf
  v_add_f32_dpp v23, v23, v23 row_ror:2 row_mask:0xf bank_mask:0xf
  v_add_f32_dpp v24, v24, v24 row_ror:2 row_mask:0xf bank_mask:0xf
  v_add_f32_dpp v25, v25, v25 row_ror:2 row_mask:0xf bank_mask:0xf
  v_add_f32_dpp v26, v26, v26 row_ror:2 row_mask:0xf bank_mask:0xf
  v_add_f32_dpp v27, v27, v27 row_ror:2 row_mask:0xf bank_mask:0xf
  v_add_f32_dpp v56, v56, v56 row_ror:1 row_mask:0xf bank_mask:0xf
  v_rcp_f32 v56, v56
  v_add_f32_dpp v20, v20, v20 row_ror:1 row_mask:0xf bank_mask:0xf
  v_add_f32_dpp v21, v21, v21 row_ror:1 row_mask:0xf bank_mask:0xf
  v_add_f32_dpp v22, v22, v22 row_ror:1 row_mask:0xf bank_mask:0xf
  v_add_f32_dpp v23, v23, v23 row_ror:1 row_mask:0xf bank_mask:0xf
  v_add_f32_dpp v24, v24, v24 row_ror:1 row_mask:0xf bank_mask:0xf
  v_add_f32_dpp v25, v25, v25 row_ror:1 row_mask:0xf bank_mask:0xf
  v_add_f32_dpp v26, v26, v26 row_ror:1 row_mask:0xf bank_mask:0xf
  v_add_f32_dpp v27, v27, v27 row_ror:1 row_mask:0xf bank_mask:0xf
  v_mul_f32 v20, v20, v56
  v_cvt_pk_bf16_f32 v20, v20, v20
  v_and_b32 v64, v20, v8
  v_and_b32 v65, v20, v9
  v_and_b32 v66, v20, v10
  v_and_b32 v67, v20, v11
  v_mul_f32 v21, v21, v56
  v_cvt_pk_bf16_f32 v21, v21, v21
  v_and_b32 v68, v21, v8
  v_and_b32 v69, v21, v9
  v_and_b32 v70, v21, v10
  v_and_b32 v71, v21, v11
  v_mfma_f32_16x16x32_bf16 v[96:99], v[64:67], v[128:131], 0
  v_mul_f32 v22, v22, v56
  v_cvt_pk_bf16_f32 v22, v22, v22
  v_mfma_f32_16x16x32_bf16 v[100:103], v[64:67], v[132:135], 0
  v_and_b32 v72, v22, v8
  v_and_b32 v73, v22, v9
  v_mfma_f32_16x16x32_bf16 v[104:107], v[64:67], v[136:139], 0
  v_and_b32 v74, v22, v10
  v_and_b32 v75, v22, v11
  v_mfma_f32_16x16x32_bf16 v[108:111], v[64:67], v[140:143], 0
  v_mfma_f32_16x16x32_bf16 v[96:99], v[68:71], v[144:147], v[96:99]
  v_mul_f32 v23, v23, v56
  v_cvt_pk_bf16_f32 v23, v23, v23
  v_mfma_f32_16x16x32_bf16 v[100:103], v[68:71], v[148:151], v[100:103]
  v_and_b32 v76, v23, v8
  v_and_b32 v77, v23, v9
  v_mfma_f32_16x16x32_bf16 v[104:107], v[68:71], v[152:155], v[104:107]
  v_and_b32 v78, v23, v10
  v_and_b32 v79, v23, v11
  v_mfma_f32_16x16x32_bf16 v[108:111], v[68:71], v[156:159], v[108:111]
  v_mfma_f32_16x16x32_bf16 v[96:99], v[72:75], v[160:163], v[96:99]
  v_mul_f32 v24, v24, v56
  v_cvt_pk_bf16_f32 v24, v24, v24
  v_mfma_f32_16x16x32_bf16 v[100:103], v[72:75], v[164:167], v[100:103]
  v_and_b32 v80, v24, v8
  v_and_b32 v81, v24, v9
  v_mfma_f32_16x16x32_bf16 v[104:107], v[72:75], v[168:171], v[104:107]
  v_and_b32 v82, v24, v10
  v_and_b32 v83, v24, v11
  v_mfma_f32_16x16x32_bf16 v[108:111], v[72:75], v[172:175], v[108:111]
  v_mfma_f32_16x16x32_bf16 v[96:99], v[76:79], v[176:179], v[96:99]
  v_mul_f32 v25, v25, v56
  v_cvt_pk_bf16_f32 v25, v25, v25
  v_mfma_f32_16x16x32_bf16 v[100:103], v[76:79], v[180:183], v[100:103]
  v_and_b32 v84, v25, v8
  v_and_b32 v85, v25, v9
  v_mfma_f32_16x16x32_bf16 v[104:107], v[76:79], v[184:187], v[104:107]
  v_and_b32 v86, v25, v10
  v_and_b32 v87, v25, v11
  v_mfma_f32_16x16x32_bf16 v[108:111], v[76:79], v[188:191], v[108:111]
  v_mfma_f32_16x16x32_bf16 v[96:99], v[80:83], v[192:195], v[96:99]
  v_mul_f32 v26, v26, v56
  v_cvt_pk_bf16_f32 v26, v26, v26
  v_mfma_f32_16x16x32_bf16 v[100:103], v[80:83], v[196:199], v[100:103]
  v_and_b32 v88, v26, v8
  v_and_b32 v89, v26, v9
  v_mfma_f32_16x16x32_bf16 v[104:107], v[80:83], v[200:203], v[104:107]
  v_and_b32 v90, v26, v10
  v_and_b32 v91, v26, v11
  v_mfma_f32_16x16x32_bf16 v[108:111], v[80:83], v[204:207], v[108:111]
  v_mfma_f32_16x16x32_bf16 v[96:99], v[84:87], v[208:211], v[96:99]
  v_mul_f32 v27, v27, v56
  v_cvt_pk_bf16_f32 v27, v27, v27
  v_mfma_f32_16x16x32_bf16 v[100:103], v[84:87], v[212:215], v[100:103]
  v_and_b32 v92, v27, v8
  v_and_b32 v93, v27, v9
  v_mfma_f32_16x16x32_bf16 v[104:107], v[84:87], v[216:219], v[104:107]
  v_and_b32 v94, v27, v10
  v_and_b32 v95, v27, v11
  v_mfma_f32_16x16x32_bf16 v[108:111], v[84:87], v[220:223], v[108:111]
  v_mfma_f32_16x16x32_bf16 v[96:99], v[88:91], v[224:227], v[96:99]
  v_mfma_f32_16x16x32_bf16 v[100:103], v[88:91], v[228:231], v[100:103]
  v_mfma_f32_16x16x32_bf16 v[104:107], v[88:91], v[232:235], v[104:107]
  v_mfma_f32_16x16x32_bf16 v[108:111], v[88:91], v[236:239], v[108:111]
  v_mfma_f32_16x16x32_bf16 v[96:99], v[92:95], v[240:243], v[96:99]
  v_mfma_f32_16x16x32_bf16 v[100:103], v[92:95], v[244:247], v[100:103]
  v_mfma_f32_16x16x32_bf16 v[104:107], v[92:95], v[248:251], v[104:107]
  v_mfma_f32_16x16x32_bf16 v[108:111], v[92:95], v[252:255], v[108:111]
  s_mov_b32 exec_hi, 0
  s_nop 3
  v_min_u32 v96, v96, v12
  v_min_u32 v97, v97, v12
  v_min_u32 v98, v98, v12
  v_min_u32 v99, v99, v12
  buffer_store_dwordx4 v[96:99], v62, s[52:55], s69 offen offset:0 sc1
  v_min_u32 v100, v100, v12
  v_min_u32 v101, v101, v12
  v_min_u32 v102, v102, v12
  v_min_u32 v103, v103, v12
  buffer_store_dwordx4 v[100:103], v62, s[52:55], s69 offen offset:512 sc1
  v_min_u32 v104, v104, v12
  v_min_u32 v105, v105, v12
  v_min_u32 v106, v106, v12
  v_min_u32 v107, v107, v12
  buffer_store_dwordx4 v[104:107], v62, s[52:55], s69 offen offset:1024 sc1
  s_mov_b32 exec_lo, 0x00ff00ff
  v_min_u32 v108, v108, v12
  v_min_u32 v109, v109, v12
  v_min_u32 v110, v110, v12
  v_min_u32 v111, v111, v12
  buffer_store_dwordx4 v[108:111], v62, s[52:55], s69 offen offset:1536 sc1
  s_mov_b64 exec, -1
  s_cmp_ge_u32 s3, 56
  s_cbranch_scc1 L_hdone
  s_mov_b32 s74, 200000
  s_mov_b32 s9, s8
  buffer_load_dwordx4 v[192:195], v13, s[52:55], s9 offen sc1
  s_add_u32 s9, s8, 196608
  buffer_load_dwordx4 v[196:199], v13, s[52:55], s9 offen sc1
  s_add_u32 s9, s8, 393216
  buffer_load_dwordx4 v[200:203], v13, s[52:55], s9 offen sc1
  s_add_u32 s9, s8, 589824
  buffer_load_dwordx4 v[204:207], v13, s[52:55], s9 offen sc1
  s_add_u32 s9, s8, 786432
  buffer_load_dwordx4 v[208:211], v13, s[52:55], s9 offen sc1
  s_add_u32 s9, s8, 983040
  buffer_load_dwordx4 v[212:215], v13, s[52:55], s9 offen sc1
  s_add_u32 s9, s8, 1179648
  buffer_load_dwordx4 v[216:219], v13, s[52:55], s9 offen sc1
  s_add_u32 s9, s8, 1376256
  buffer_load_dwordx4 v[220:223], v13, s[52:55], s9 offen sc1
  s_mov_b32 s9, s8
  buffer_load_dwordx4 v[192:195], v13, s[52:55], s9 offen sc1
  s_add_u32 s9, s8, 196608
  buffer_load_dwordx4 v[196:199], v13, s[52:55], s9 offen sc1
  s_add_u32 s9, s8, 393216
  buffer_load_dwordx4 v[200:203], v13, s[52:55], s9 offen sc1
  s_add_u32 s9, s8, 589824
  buffer_load_dwordx4 v[204:207], v13, s[52:55], s9 offen sc1
  s_add_u32 s9, s8, 786432
  buffer_load_dwordx4 v[208:211], v13, s[52:55], s9 offen sc1
  s_add_u32 s9, s8, 983040
  buffer_load_dwordx4 v[212:215], v13, s[52:55], s9 offen sc1
  s_add_u32 s9, s8, 1179648
  buffer_load_dwordx4 v[216:219], v13, s[52:55], s9 offen sc1
  s_add_u32 s9, s8, 1376256
  buffer_load_dwordx4 v[220:223], v13, s[52:55], s9 offen sc1
L_p2:
  s_mov_b32 s9, s8
  buffer_load_dwordx4 v[192:195], v13, s[52:55], s9 offen sc1
  s_add_u32 s9, s8, 196608
  buffer_load_dwordx4 v[196:199], v13, s[52:55], s9 offen sc1
  s_add_u32 s9, s8, 393216
  buffer_load_dwordx4 v[200:203], v13, s[52:55], s9 offen sc1
  s_add_u32 s9, s8, 589824
  buffer_load_dwordx4 v[204:207], v13, s[52:55], s9 offen sc1
  s_add_u32 s9, s8, 786432
  buffer_load_dwordx4 v[208:211], v13, s[52:55], s9 offen sc1
  s_add_u32 s9, s8, 983040
  buffer_load_dwordx4 v[212:215], v13, s[52:55], s9 offen sc1
  s_add_u32 s9, s8, 1179648
  buffer_load_dwordx4 v[216:219], v13, s[52:55], s9 offen sc1
  s_add_u32 s9, s8, 1376256
  buffer_load_dwordx4 v[220:223], v13, s[52:55], s9 offen sc1
  s_waitcnt vmcnt(16)
  v_mov_b64 v[128:129], v[192:193]
  v_mov_b64 v[130:131], v[194:195]
  v_mov_b64 v[132:133], v[196:197]
  v_mov_b64 v[134:135], v[198:199]
  v_mov_b64 v[136:137], v[200:201]
  v_mov_b64 v[138:139], v[202:203]
  v_mov_b64 v[140:141], v[204:205]
  v_mov_b64 v[142:143], v[206:207]
  v_mov_b64 v[144:145], v[208:209]
  v_mov_b64 v[146:147], v[210:211]
  v_mov_b64 v[148:149], v[212:213]
  v_mov_b64 v[150:151], v[214:215]
  v_mov_b64 v[152:153], v[216:217]
  v_mov_b64 v[154:155], v[218:219]
  v_mov_b64 v[156:157], v[220:221]
  v_mov_b64 v[158:159], v[222:223]
  v_max3_u32 v16, v128, v129, v130
  v_max3_u32 v17, v136, v137, v138
  v_max3_u32 v18, v144, v145, v146
  v_max3_u32 v19, v152, v153, v154
  v_max3_u32 v16, v16, v131, v132
  v_max3_u32 v17, v17, v139, v140
  v_max3_u32 v18, v18, v147, v148
  v_max3_u32 v19, v19, v155, v156
  v_max3_u32 v16, v16, v133, v134
  v_max3_u32 v17, v17, v141, v142
  v_max3_u32 v18, v18, v149, v150
  v_max3_u32 v19, v19, v157, v158
  v_max_u32 v16, v16, v135
  v_max_u32 v17, v17, v143
  v_max_u32 v18, v18, v151
  v_max_u32 v19, v19, v159
  v_max3_u32 v16, v16, v17, v18
  v_max_u32 v16, v16, v19
  v_cmp_eq_u32 vcc, -1, v16
  s_sub_u32 s74, s74, 1
  s_cbranch_scc1 L_p2got
  s_and_b64 exec, exec, vcc
  s_cbranch_scc1 L_p2
L_p2got:
  s_mov_b64 exec, -1
  v_add_f32 v128, v128, v144
  v_add_f32 v129, v129, v145
  v_add_f32 v130, v130, v146
  v_add_f32 v131, v131, v147
  v_add_f32 v132, v132, v148
  v_add_f32 v133, v133, v149
  v_add_f32 v134, v134, v150
  v_add_f32 v135, v135, v151
  v_add_f32 v136, v136, v152
  v_add_f32 v137, v137, v153
  v_add_f32 v138, v138, v154
  v_add_f32 v139, v139, v155
  v_add_f32 v140, v140, v156
  v_add_f32 v141, v141, v157
  v_add_f32 v142, v142, v158
  v_add_f32 v143, v143, v159
  v_add_f32 v128, v128, v136
  v_add_f32 v129, v129, v137
  v_add_f32 v130, v130, v138
  v_add_f32 v131, v131, v139
  v_add_f32 v132, v132, v140
  v_add_f32 v133, v133, v141
  v_add_f32 v134, v134, v142
  v_add_f32 v135, v135, v143
  v_add_f32 v128, v128, v132
  v_add_f32 v129, v129, v133
  v_add_f32 v130, v130, v134
  v_add_f32 v131, v131, v135
  s_nop 0
  v_add_f32_dpp v128, v128, v128 row_ror:4 row_mask:0xf bank_mask:0xf
  v_add_f32_dpp v129, v129, v129 row_ror:4 row_mask:0xf bank_mask:0xf
  v_add_f32_dpp v130, v130, v130 row_ror:4 row_mask:0xf bank_mask:0xf
  v_add_f32_dpp v131, v131, v131 row_ror:4 row_mask:0xf bank_mask:0xf
  s_nop 0
  v_add_f32_dpp v128, v128, v128 row_ror:8 row_mask:0xf bank_mask:0xf
  v_add_f32_dpp v129, v129, v129 row_ror:8 row_mask:0xf bank_mask:0xf
  v_add_f32_dpp v130, v130, v130 row_ror:8 row_mask:0xf bank_mask:0xf
  v_add_f32_dpp v131, v131, v131 row_ror:8 row_mask:0xf bank_mask:0xf
  v_mov_b32 v20, v128
  v_mov_b32 v21, v129
  v_mov_b32 v22, v130
  v_mov_b32 v23, v131
  s_nop 1
  v_permlane16_swap_b32 v128, v20
  v_permlane16_swap_b32 v129, v21
  v_permlane16_swap_b32 v130, v22
  v_permlane16_swap_b32 v131, v23
  s_nop 0
  v_add_f32 v128, v128, v20
  v_add_f32 v129, v129, v21
  v_add_f32 v130, v130, v22
  v_add_f32 v131, v131, v23
  v_mov_b32 v20, v128
  v_mov_b32 v21, v129
  v_mov_b32 v22, v130
  v_mov_b32 v23, v131
  s_nop 1
  v_permlane32_swap_b32 v128, v20
  v_permlane32_swap_b32 v129, v21
  v_permlane32_swap_b32 v130, v22
  v_permlane32_swap_b32 v131, v23
  s_nop 0
  v_add_f32 v128, v128, v20
  v_add_f32 v129, v129, v21
  v_add_f32 v130, v130, v22
  v_add_f32 v131, v131, v23
  v_cvt_pk_bf16_f32 v20, v128, v129
  v_cvt_pk_bf16_f32 v21, v130, v131
  s_mov_b64 exec, 15
  buffer_store_dwordx2 v[20:21], v63, s[56:59], s12 offen
  s_cmp_lg_u32 s2, 0
  s_cbranch_scc1 L_noep
  s_mov_b64 exec, 1
  v_mov_b32 v16, s66
  buffer_store_dword v16, v63, s[52:55], 0 offen offset:0
L_noep:
  s_mov_b64 exec, -1
L_hdone:
L_end:
  s_endpgm
.section .rodata,"a"
.p2align 6
.amdhsa_kernel concat_heads__gqa_block_cached__mha_block_cached__decode_kernel
  .amdhsa_next_free_vgpr 256
  .amdhsa_next_free_sgpr 80
  .amdhsa_accum_offset 256
  .amdhsa_group_segment_fixed_size 0
  .amdhsa_kernarg_size 104
  .amdhsa_user_sgpr_count 2
  .amdhsa_user_sgpr_kernarg_segment_ptr 1
  .amdhsa_system_sgpr_workgroup_id_x 1
.end_amdhsa_kernel
```
